```python
import torch

def _softmax(x, axis=-1):
    return torch.softmax(x, dim=axis)
def _gelu(x):
    return torch.nn.functional.gelu(x, approximate="tanh")
def _silu(x):
    return torch.nn.functional.silu(x)
def _sigmoid(x):
    return torch.sigmoid(x)
def _layernorm(x, axis=-1, eps=1e-5):
    m = x.mean(dim=axis, keepdim=True)
    v = x.var(dim=axis, keepdim=True, unbiased=False)
    return (x - m) / torch.sqrt(v + eps)
def _scatter_add(tgt, idx, src, axis=0):
    return tgt.clone().index_add_(axis, idx, src)
def _segment_sum(src, seg, n):
    out = torch.zeros((n,) + src.shape[1:], dtype=src.dtype)
    return out.index_add_(0, seg, src)
def _pad(x, pw):
    flat = tuple(v for pair in reversed(pw) for v in pair)
    return torch.nn.functional.pad(x, flat)

kernel_name = 'standalone__gqa_softmax__sampling'

def setup_inputs():

    _w = (lambda a: (lambda t: t.to(torch.bfloat16) if t.is_floating_point() else t)(torch.as_tensor(a)))
    B, Hq, Hkv, Sq, Sk, D = 8, 16, 8, 8, 8192, 256
    return {
        "q": _w((lambda *s: torch.randn(*s, dtype=torch.bfloat16) * 0.8)(B, Hq, Sq, D)),
        "k": _w((lambda *s: torch.randn(*s, dtype=torch.bfloat16) * 0.8)(B, Hkv, Sk, D)),
        "v": _w((lambda *s: torch.randn(*s, dtype=torch.bfloat16) * 0.05)(B, Hkv, Sk, D)),
    }

def reference(q, k, v):
    B, Hq, Sq, D = q.shape
    Hkv = k.shape[1]
    rep = Hq // Hkv
    k = (lambda x, n, axis: torch.repeat_interleave(x, n, dim=axis))(k, rep, axis=1)
    v = (lambda x, n, axis: torch.repeat_interleave(x, n, dim=axis))(v, rep, axis=1)
    scale = D ** -0.5
    scores = torch.einsum("bhqd,bhkd->bhqk", q, k) * scale
    p = _softmax(scores, axis=-1)
    return torch.einsum("bhqk,bhkd->bhqd", p, v)
```

```asm
; @launch grid=(256,1,1) block=(192,1,1) lds=143360
.amdgcn_target "amdgcn-amd-amdhsa--gfx950"
.text
.globl standalone__gqa_softmax__sampling_kernel
.p2align 8
.type standalone__gqa_softmax__sampling_kernel,@function
standalone__gqa_softmax__sampling_kernel:
    s_cmp_ge_u32 s2, 256
    s_cbranch_scc1 L_end
    s_load_dwordx8 s[4:11], s[0:1], 0
    s_load_dwordx4 s[12:15], s[0:1], 32
    v_lshrrev_b32 v1, 6, v0
    v_and_b32 v0, 63, v0
    s_lshr_b32 s28, s2, 2
    s_and_b32 s29, s2, 3
    v_readfirstlane_b32 s3, v1
    v_and_b32 v1, 31, v0
    v_lshrrev_b32 v2, 5, v0
    v_lshlrev_b32 v1, 4, v1
    s_lshl_b32 s35, s28, 2
    s_cmp_lg_u32 s3, 2
    s_cbranch_scc1 L_consumer
    v_lshl_or_b32 v3, v2, 13, v1
    v_xor_b32 v8, 0x0, v3
    v_xor_b32 v9, 0x220, v3
    v_xor_b32 v10, 0x440, v3
    v_xor_b32 v11, 0x660, v3
    v_xor_b32 v12, 0x880, v3
    v_xor_b32 v13, 0xaa0, v3
    v_xor_b32 v14, 0xcc0, v3
    v_xor_b32 v15, 0xee0, v3
    s_bfe_u32 s94, s29, 0x10000
    s_lshl_b32 s94, s94, 12
    s_bfe_u32 s55, s29, 0x10001
    s_lshl_b32 s55, s55, 21
    s_or_b32 s94, s94, s55
    s_mov_b32 s95, 0
    s_lshl_b32 s63, s28, 22
    s_xor_b32 s80, s94, 0
    s_xor_b32 s81, s94, 16384
    s_xor_b32 s82, s94, 65536
    s_xor_b32 s83, s94, 81920
    s_mov_b32 s53, 15
    s_waitcnt lgkmcnt(0)
    s_add_u32 s16, s6, s63
    s_addc_u32 s17, s7, 0
    s_and_b32 s17, s17, 0xffff
    s_mov_b32 s18, 0x400000
    s_mov_b32 s19, 0x20000
    s_mov_b32 m0, 0
    s_nop 0
    buffer_load_dwordx4 v8, s[16:19], s80 offen nt lds
    s_mov_b32 m0, 65536
    s_nop 0
    buffer_load_dwordx4 v8, s[16:19], s82 offen nt lds
    s_mov_b32 m0, 1024
    s_nop 0
    buffer_load_dwordx4 v9, s[16:19], s80 offen nt lds
    s_mov_b32 m0, 66560
    s_nop 0
    buffer_load_dwordx4 v9, s[16:19], s82 offen nt lds
    s_mov_b32 m0, 2048
    s_nop 0
    buffer_load_dwordx4 v10, s[16:19], s80 offen nt lds
    s_mov_b32 m0, 67584
    s_nop 0
    buffer_load_dwordx4 v10, s[16:19], s82 offen nt lds
    s_mov_b32 m0, 3072
    s_nop 0
    buffer_load_dwordx4 v11, s[16:19], s80 offen nt lds
    s_mov_b32 m0, 68608
    s_nop 0
    buffer_load_dwordx4 v11, s[16:19], s82 offen nt lds
    s_mov_b32 m0, 4096
    s_nop 0
    buffer_load_dwordx4 v12, s[16:19], s80 offen nt lds
    s_mov_b32 m0, 69632
    s_nop 0
    buffer_load_dwordx4 v12, s[16:19], s82 offen nt lds
    s_mov_b32 m0, 5120
    s_nop 0
    buffer_load_dwordx4 v13, s[16:19], s80 offen nt lds
    s_mov_b32 m0, 70656
    s_nop 0
    buffer_load_dwordx4 v13, s[16:19], s82 offen nt lds
    s_mov_b32 m0, 6144
    s_nop 0
    buffer_load_dwordx4 v14, s[16:19], s80 offen nt lds
    s_mov_b32 m0, 71680
    s_nop 0
    buffer_load_dwordx4 v14, s[16:19], s82 offen nt lds
    s_mov_b32 m0, 7168
    s_nop 0
    buffer_load_dwordx4 v15, s[16:19], s80 offen nt lds
    s_mov_b32 m0, 72704
    s_nop 0
    buffer_load_dwordx4 v15, s[16:19], s82 offen nt lds
    s_mov_b32 m0, 8192
    s_nop 0
    buffer_load_dwordx4 v8, s[16:19], s81 offen nt lds
    s_mov_b32 m0, 73728
    s_nop 0
    buffer_load_dwordx4 v8, s[16:19], s83 offen nt lds
    s_mov_b32 m0, 9216
    s_nop 0
    buffer_load_dwordx4 v9, s[16:19], s81 offen nt lds
    s_mov_b32 m0, 74752
    s_nop 0
    buffer_load_dwordx4 v9, s[16:19], s83 offen nt lds
    s_add_u32 s20, s8, s63
    s_addc_u32 s21, s9, 0
    s_and_b32 s21, s21, 0xffff
    s_mov_b32 s22, 0x400000
    s_mov_b32 s23, 0x20000
    s_add_u32 s58, s12, s35
    s_addc_u32 s59, s13, 0
    v_mov_b32 v4, 132096
    s_lshl_b32 s55, s28, 9
    s_add_u32 s55, s55, 0x500000
    s_add_u32 s48, s14, s55
    s_addc_u32 s49, s15, 0
    s_lshl_b32 s55, s29, 7
    s_add_u32 s50, s48, s55
    s_addc_u32 s51, s49, 0
    s_load_dwordx2 s[56:57], s[50:51], 0 glc
    v_mov_b32 v16, s94
    v_bfe_u32 v5, v0, 0, 1
    v_lshlrev_b32 v5, 15, v5
    v_xor_b32 v16, v5, v16
    v_bfe_u32 v5, v0, 1, 1
    v_lshlrev_b32 v5, 17, v5
    v_xor_b32 v16, v5, v16
    v_bfe_u32 v5, v0, 2, 1
    v_lshlrev_b32 v5, 18, v5
    v_xor_b32 v16, v5, v16
    v_bfe_u32 v5, v0, 3, 1
    v_lshlrev_b32 v5, 19, v5
    v_xor_b32 v16, v5, v16
    v_bfe_u32 v5, v0, 4, 1
    v_lshlrev_b32 v5, 20, v5
    v_xor_b32 v16, v5, v16
    s_nop 0
    s_add_u32 s95, s95, 1
    v_readlane_b32 s60, v16, s95
    s_nop 3
    s_xor_b32 s84, s60, 0
    s_xor_b32 s85, s60, 16384
    s_xor_b32 s86, s60, 65536
    s_xor_b32 s87, s60, 81920
    s_waitcnt vmcnt(19)
    s_mov_b32 m0, 10240
    s_nop 0
    buffer_load_dwordx4 v10, s[16:19], s81 offen nt lds
    s_waitcnt vmcnt(19)
    s_mov_b32 m0, 75776
    s_nop 0
    buffer_load_dwordx4 v10, s[16:19], s83 offen nt lds
    s_waitcnt vmcnt(19)
    s_mov_b32 m0, 11264
    s_nop 0
    buffer_load_dwordx4 v11, s[16:19], s81 offen nt lds
    s_waitcnt vmcnt(19)
    s_mov_b32 m0, 76800
    s_nop 0
    buffer_load_dwordx4 v11, s[16:19], s83 offen nt lds
    s_waitcnt vmcnt(19)
    s_mov_b32 m0, 12288
    s_nop 0
    buffer_load_dwordx4 v12, s[16:19], s81 offen nt lds
    s_waitcnt vmcnt(19)
    s_mov_b32 m0, 77824
    s_nop 0
    buffer_load_dwordx4 v12, s[16:19], s83 offen nt lds
    s_waitcnt vmcnt(19)
    s_mov_b32 m0, 13312
    s_nop 0
    buffer_load_dwordx4 v13, s[16:19], s81 offen nt lds
    s_waitcnt vmcnt(19)
    s_mov_b32 m0, 78848
    s_nop 0
    buffer_load_dwordx4 v13, s[16:19], s83 offen nt lds
    s_waitcnt vmcnt(19)
    s_mov_b32 m0, 14336
    s_nop 0
    buffer_load_dwordx4 v14, s[16:19], s81 offen nt lds
    s_waitcnt vmcnt(19)
    s_mov_b32 m0, 79872
    s_nop 0
    buffer_load_dwordx4 v14, s[16:19], s83 offen nt lds
    s_waitcnt vmcnt(19)
    s_mov_b32 m0, 15360
    s_nop 0
    buffer_load_dwordx4 v15, s[16:19], s81 offen nt lds
    s_waitcnt vmcnt(19)
    s_mov_b32 m0, 80896
    s_nop 0
    buffer_load_dwordx4 v15, s[16:19], s83 offen nt lds
    s_waitcnt vmcnt(19)
    s_mov_b32 m0, 16384
    s_nop 0
    buffer_load_dwordx4 v8, s[20:23], s80 offen nt lds
    s_waitcnt vmcnt(19)
    s_mov_b32 m0, 81920
    s_nop 0
    buffer_load_dwordx4 v8, s[20:23], s82 offen nt lds
    s_waitcnt vmcnt(19)
    s_mov_b32 m0, 17408
    s_nop 0
    buffer_load_dwordx4 v9, s[20:23], s80 offen nt lds
    s_waitcnt vmcnt(19)
    s_mov_b32 m0, 82944
    s_nop 0
    buffer_load_dwordx4 v9, s[20:23], s82 offen nt lds
    s_waitcnt vmcnt(19)
    s_mov_b32 m0, 18432
    s_nop 0
    buffer_load_dwordx4 v10, s[20:23], s80 offen nt lds
    s_waitcnt vmcnt(19)
    s_mov_b32 m0, 83968
    s_nop 0
    buffer_load_dwordx4 v10, s[20:23], s82 offen nt lds
    s_waitcnt vmcnt(19)
    s_mov_b32 m0, 19456
    s_nop 0
    buffer_load_dwordx4 v11, s[20:23], s80 offen nt lds
    s_waitcnt vmcnt(19)
    s_mov_b32 m0, 84992
    s_nop 0
    buffer_load_dwordx4 v11, s[20:23], s82 offen nt lds
    s_waitcnt vmcnt(19)
    s_mov_b32 m0, 20480
    s_nop 0
    buffer_load_dwordx4 v12, s[20:23], s80 offen nt lds
    s_waitcnt vmcnt(19)
    s_mov_b32 m0, 86016
    s_nop 0
    buffer_load_dwordx4 v12, s[20:23], s82 offen nt lds
    s_waitcnt vmcnt(19)
    s_mov_b32 m0, 21504
    s_nop 0
    buffer_load_dwordx4 v13, s[20:23], s80 offen nt lds
    s_waitcnt vmcnt(19)
    s_mov_b32 m0, 87040
    s_nop 0
    buffer_load_dwordx4 v13, s[20:23], s82 offen nt lds
    s_waitcnt vmcnt(19)
    s_mov_b32 m0, 22528
    s_nop 0
    buffer_load_dwordx4 v14, s[20:23], s80 offen nt lds
    s_waitcnt vmcnt(19)
    s_mov_b32 m0, 88064
    s_nop 0
    buffer_load_dwordx4 v14, s[20:23], s82 offen nt lds
    s_waitcnt vmcnt(19)
    s_mov_b32 m0, 23552
    s_nop 0
    buffer_load_dwordx4 v15, s[20:23], s80 offen nt lds
    s_waitcnt vmcnt(19)
    s_mov_b32 m0, 89088
    s_nop 0
    buffer_load_dwordx4 v15, s[20:23], s82 offen nt lds
    s_waitcnt vmcnt(19)
    s_mov_b32 m0, 24576
    s_nop 0
    buffer_load_dwordx4 v8, s[20:23], s81 offen nt lds
    s_waitcnt vmcnt(19)
    s_mov_b32 m0, 90112
    s_nop 0
    buffer_load_dwordx4 v8, s[20:23], s83 offen nt lds
    s_waitcnt vmcnt(19)
    s_mov_b32 m0, 25600
    s_nop 0
    buffer_load_dwordx4 v9, s[20:23], s81 offen nt lds
    s_waitcnt vmcnt(19)
    s_mov_b32 m0, 91136
    s_nop 0
    buffer_load_dwordx4 v9, s[20:23], s83 offen nt lds
    s_barrier
    s_waitcnt vmcnt(19)
    s_mov_b32 m0, 26624
    s_nop 0
    buffer_load_dwordx4 v10, s[20:23], s81 offen nt lds
    s_waitcnt vmcnt(19)
    s_mov_b32 m0, 92160
    s_nop 0
    buffer_load_dwordx4 v10, s[20:23], s83 offen nt lds
    s_waitcnt vmcnt(19)
    s_mov_b32 m0, 27648
    s_nop 0
    buffer_load_dwordx4 v11, s[20:23], s81 offen nt lds
    s_waitcnt vmcnt(19)
    s_mov_b32 m0, 93184
    s_nop 0
    buffer_load_dwordx4 v11, s[20:23], s83 offen nt lds
    s_waitcnt vmcnt(19)
    s_mov_b32 m0, 28672
    s_nop 0
    buffer_load_dwordx4 v12, s[20:23], s81 offen nt lds
    s_waitcnt vmcnt(19)
    s_mov_b32 m0, 94208
    s_nop 0
    buffer_load_dwordx4 v12, s[20:23], s83 offen nt lds
    s_waitcnt vmcnt(19)
    s_mov_b32 m0, 29696
    s_nop 0
    buffer_load_dwordx4 v13, s[20:23], s81 offen nt lds
    s_waitcnt vmcnt(19)
    s_mov_b32 m0, 95232
    s_nop 0
    buffer_load_dwordx4 v13, s[20:23], s83 offen nt lds
    s_waitcnt vmcnt(19)
    s_mov_b32 m0, 30720
    s_nop 0
    buffer_load_dwordx4 v14, s[20:23], s81 offen nt lds
    s_waitcnt vmcnt(19)
    s_mov_b32 m0, 96256
    s_nop 0
    buffer_load_dwordx4 v14, s[20:23], s83 offen nt lds
    s_waitcnt vmcnt(19)
    s_mov_b32 m0, 31744
    s_nop 0
    buffer_load_dwordx4 v15, s[20:23], s81 offen nt lds
    s_waitcnt vmcnt(19)
    s_mov_b32 m0, 97280
    s_nop 0
    buffer_load_dwordx4 v15, s[20:23], s83 offen nt lds
    s_waitcnt vmcnt(19)
    s_mov_b32 m0, 32768
    s_nop 0
    buffer_load_dwordx4 v8, s[16:19], s84 offen nt lds
    s_waitcnt vmcnt(19)
    s_mov_b32 m0, 98304
    s_nop 0
    buffer_load_dwordx4 v8, s[16:19], s86 offen nt lds
    s_waitcnt vmcnt(19)
    s_mov_b32 m0, 33792
    s_nop 0
    buffer_load_dwordx4 v9, s[16:19], s84 offen nt lds
    s_waitcnt vmcnt(19)
    s_mov_b32 m0, 99328
    s_nop 0
    buffer_load_dwordx4 v9, s[16:19], s86 offen nt lds
    s_waitcnt vmcnt(19)
    s_mov_b32 m0, 34816
    s_nop 0
    buffer_load_dwordx4 v10, s[16:19], s84 offen nt lds
    s_waitcnt vmcnt(19)
    s_mov_b32 m0, 100352
    s_nop 0
    buffer_load_dwordx4 v10, s[16:19], s86 offen nt lds
    s_waitcnt vmcnt(19)
    s_mov_b32 m0, 35840
    s_nop 0
    buffer_load_dwordx4 v11, s[16:19], s84 offen nt lds
    s_waitcnt vmcnt(19)
    s_mov_b32 m0, 101376
    s_nop 0
    buffer_load_dwordx4 v11, s[16:19], s86 offen nt lds
    s_waitcnt vmcnt(19)
    s_mov_b32 m0, 36864
    s_nop 0
    buffer_load_dwordx4 v12, s[16:19], s84 offen nt lds
    s_waitcnt vmcnt(19)
    s_mov_b32 m0, 102400
    s_nop 0
    buffer_load_dwordx4 v12, s[16:19], s86 offen nt lds
    s_waitcnt vmcnt(19)
    s_mov_b32 m0, 37888
    s_nop 0
    buffer_load_dwordx4 v13, s[16:19], s84 offen nt lds
    s_waitcnt vmcnt(19)
    s_mov_b32 m0, 103424
    s_nop 0
    buffer_load_dwordx4 v13, s[16:19], s86 offen nt lds
    s_waitcnt vmcnt(19)
    s_mov_b32 m0, 38912
    s_nop 0
    buffer_load_dwordx4 v14, s[16:19], s84 offen nt lds
    s_waitcnt vmcnt(19)
    s_mov_b32 m0, 104448
    s_nop 0
    buffer_load_dwordx4 v14, s[16:19], s86 offen nt lds
    s_waitcnt vmcnt(19)
    s_mov_b32 m0, 39936
    s_nop 0
    buffer_load_dwordx4 v15, s[16:19], s84 offen nt lds
    s_waitcnt vmcnt(19)
    s_mov_b32 m0, 105472
    s_nop 0
    buffer_load_dwordx4 v15, s[16:19], s86 offen nt lds
    s_waitcnt vmcnt(19)
    s_mov_b32 m0, 40960
    s_nop 0
    buffer_load_dwordx4 v8, s[16:19], s85 offen nt lds
    s_waitcnt vmcnt(19)
    s_mov_b32 m0, 106496
    s_nop 0
    buffer_load_dwordx4 v8, s[16:19], s87 offen nt lds
    s_waitcnt vmcnt(19)
    s_mov_b32 m0, 41984
    s_nop 0
    buffer_load_dwordx4 v9, s[16:19], s85 offen nt lds
    s_waitcnt vmcnt(19)
    s_mov_b32 m0, 107520
    s_nop 0
    buffer_load_dwordx4 v9, s[16:19], s87 offen nt lds
    s_barrier
    s_mov_b32 s80, s84
    s_mov_b32 s81, s85
    s_mov_b32 s82, s86
    s_mov_b32 s83, s87
    s_add_u32 s95, s95, 1
    v_readlane_b32 s60, v16, s95
    s_nop 3
    s_xor_b32 s84, s60, 0
    s_xor_b32 s85, s60, 16384
    s_xor_b32 s86, s60, 65536
    s_xor_b32 s87, s60, 81920
    s_cmp_eq_u32 s53, 0
    s_cbranch_scc1 L_llast
L_lloop:
    s_waitcnt vmcnt(19)
    s_mov_b32 m0, 43008
    s_nop 0
    buffer_load_dwordx4 v10, s[16:19], s81 offen nt lds
    s_waitcnt vmcnt(19)
    s_mov_b32 m0, 108544
    s_nop 0
    buffer_load_dwordx4 v10, s[16:19], s83 offen nt lds
    s_waitcnt vmcnt(19)
    s_mov_b32 m0, 44032
    s_nop 0
    buffer_load_dwordx4 v11, s[16:19], s81 offen nt lds
    s_waitcnt vmcnt(19)
    s_mov_b32 m0, 109568
    s_nop 0
    buffer_load_dwordx4 v11, s[16:19], s83 offen nt lds
    s_waitcnt vmcnt(19)
    s_mov_b32 m0, 45056
    s_nop 0
    buffer_load_dwordx4 v12, s[16:19], s81 offen nt lds
    s_waitcnt vmcnt(19)
    s_mov_b32 m0, 110592
    s_nop 0
    buffer_load_dwordx4 v12, s[16:19], s83 offen nt lds
    s_waitcnt vmcnt(19)
    s_mov_b32 m0, 46080
    s_nop 0
    buffer_load_dwordx4 v13, s[16:19], s81 offen nt lds
    s_waitcnt vmcnt(19)
    s_mov_b32 m0, 111616
    s_nop 0
    buffer_load_dwordx4 v13, s[16:19], s83 offen nt lds
    s_waitcnt vmcnt(19)
    s_mov_b32 m0, 47104
    s_nop 0
    buffer_load_dwordx4 v14, s[16:19], s81 offen nt lds
    s_waitcnt vmcnt(19)
    s_mov_b32 m0, 112640
    s_nop 0
    buffer_load_dwordx4 v14, s[16:19], s83 offen nt lds
    s_waitcnt vmcnt(19)
    s_mov_b32 m0, 48128
    s_nop 0
    buffer_load_dwordx4 v15, s[16:19], s81 offen nt lds
    s_waitcnt vmcnt(19)
    s_mov_b32 m0, 113664
    s_nop 0
    buffer_load_dwordx4 v15, s[16:19], s83 offen nt lds
    s_waitcnt vmcnt(19)
    s_mov_b32 m0, 49152
    s_nop 0
    buffer_load_dwordx4 v8, s[20:23], s80 offen nt lds
    s_waitcnt vmcnt(19)
    s_mov_b32 m0, 114688
    s_nop 0
    buffer_load_dwordx4 v8, s[20:23], s82 offen nt lds
    s_waitcnt vmcnt(19)
    s_mov_b32 m0, 50176
    s_nop 0
    buffer_load_dwordx4 v9, s[20:23], s80 offen nt lds
    s_waitcnt vmcnt(19)
    s_mov_b32 m0, 115712
    s_nop 0
    buffer_load_dwordx4 v9, s[20:23], s82 offen nt lds
    s_waitcnt vmcnt(19)
    s_mov_b32 m0, 51200
    s_nop 0
    buffer_load_dwordx4 v10, s[20:23], s80 offen nt lds
    s_waitcnt vmcnt(19)
    s_mov_b32 m0, 116736
    s_nop 0
    buffer_load_dwordx4 v10, s[20:23], s82 offen nt lds
    s_waitcnt vmcnt(19)
    s_mov_b32 m0, 52224
    s_nop 0
    buffer_load_dwordx4 v11, s[20:23], s80 offen nt lds
    s_waitcnt vmcnt(19)
    s_mov_b32 m0, 117760
    s_nop 0
    buffer_load_dwordx4 v11, s[20:23], s82 offen nt lds
    s_waitcnt vmcnt(19)
    s_mov_b32 m0, 53248
    s_nop 0
    buffer_load_dwordx4 v12, s[20:23], s80 offen nt lds
    s_waitcnt vmcnt(19)
    s_mov_b32 m0, 118784
    s_nop 0
    buffer_load_dwordx4 v12, s[20:23], s82 offen nt lds
    s_waitcnt vmcnt(19)
    s_mov_b32 m0, 54272
    s_nop 0
    buffer_load_dwordx4 v13, s[20:23], s80 offen nt lds
    s_waitcnt vmcnt(19)
    s_mov_b32 m0, 119808
    s_nop 0
    buffer_load_dwordx4 v13, s[20:23], s82 offen nt lds
    s_waitcnt vmcnt(19)
    s_mov_b32 m0, 55296
    s_nop 0
    buffer_load_dwordx4 v14, s[20:23], s80 offen nt lds
    s_waitcnt vmcnt(19)
    s_mov_b32 m0, 120832
    s_nop 0
    buffer_load_dwordx4 v14, s[20:23], s82 offen nt lds
    s_waitcnt vmcnt(19)
    s_mov_b32 m0, 56320
    s_nop 0
    buffer_load_dwordx4 v15, s[20:23], s80 offen nt lds
    s_waitcnt vmcnt(19)
    s_mov_b32 m0, 121856
    s_nop 0
    buffer_load_dwordx4 v15, s[20:23], s82 offen nt lds
    s_waitcnt vmcnt(19)
    s_mov_b32 m0, 57344
    s_nop 0
    buffer_load_dwordx4 v8, s[20:23], s81 offen nt lds
    s_waitcnt vmcnt(19)
    s_mov_b32 m0, 122880
    s_nop 0
    buffer_load_dwordx4 v8, s[20:23], s83 offen nt lds
    s_waitcnt vmcnt(19)
    s_mov_b32 m0, 58368
    s_nop 0
    buffer_load_dwordx4 v9, s[20:23], s81 offen nt lds
    s_waitcnt vmcnt(19)
    s_mov_b32 m0, 123904
    s_nop 0
    buffer_load_dwordx4 v9, s[20:23], s83 offen nt lds
    s_barrier
    s_waitcnt vmcnt(19)
    s_mov_b32 m0, 59392
    s_nop 0
    buffer_load_dwordx4 v10, s[20:23], s81 offen nt lds
    s_waitcnt vmcnt(19)
    s_mov_b32 m0, 124928
    s_nop 0
    buffer_load_dwordx4 v10, s[20:23], s83 offen nt lds
    s_waitcnt vmcnt(19)
    s_mov_b32 m0, 60416
    s_nop 0
    buffer_load_dwordx4 v11, s[20:23], s81 offen nt lds
    s_waitcnt vmcnt(19)
    s_mov_b32 m0, 125952
    s_nop 0
    buffer_load_dwordx4 v11, s[20:23], s83 offen nt lds
    s_waitcnt vmcnt(19)
    s_mov_b32 m0, 61440
    s_nop 0
    buffer_load_dwordx4 v12, s[20:23], s81 offen nt lds
    s_waitcnt vmcnt(19)
    s_mov_b32 m0, 126976
    s_nop 0
    buffer_load_dwordx4 v12, s[20:23], s83 offen nt lds
    s_waitcnt vmcnt(19)
    s_mov_b32 m0, 62464
    s_nop 0
    buffer_load_dwordx4 v13, s[20:23], s81 offen nt lds
    s_waitcnt vmcnt(19)
    s_mov_b32 m0, 128000
    s_nop 0
    buffer_load_dwordx4 v13, s[20:23], s83 offen nt lds
    s_waitcnt vmcnt(19)
    s_mov_b32 m0, 63488
    s_nop 0
    buffer_load_dwordx4 v14, s[20:23], s81 offen nt lds
    s_waitcnt vmcnt(19)
    s_mov_b32 m0, 129024
    s_nop 0
    buffer_load_dwordx4 v14, s[20:23], s83 offen nt lds
    s_waitcnt vmcnt(19)
    s_mov_b32 m0, 64512
    s_nop 0
    buffer_load_dwordx4 v15, s[20:23], s81 offen nt lds
    s_waitcnt vmcnt(19)
    s_mov_b32 m0, 130048
    s_nop 0
    buffer_load_dwordx4 v15, s[20:23], s83 offen nt lds
    s_waitcnt vmcnt(19)
    s_mov_b32 m0, 0
    s_nop 0
    buffer_load_dwordx4 v8, s[16:19], s84 offen nt lds
    s_waitcnt vmcnt(19)
    s_mov_b32 m0, 65536
    s_nop 0
    buffer_load_dwordx4 v8, s[16:19], s86 offen nt lds
    s_waitcnt vmcnt(19)
    s_mov_b32 m0, 1024
    s_nop 0
    buffer_load_dwordx4 v9, s[16:19], s84 offen nt lds
    s_waitcnt vmcnt(19)
    s_mov_b32 m0, 66560
    s_nop 0
    buffer_load_dwordx4 v9, s[16:19], s86 offen nt lds
    s_waitcnt vmcnt(19)
    s_mov_b32 m0, 2048
    s_nop 0
    buffer_load_dwordx4 v10, s[16:19], s84 offen nt lds
    s_waitcnt vmcnt(19)
    s_mov_b32 m0, 67584
    s_nop 0
    buffer_load_dwordx4 v10, s[16:19], s86 offen nt lds
    s_waitcnt vmcnt(19)
    s_mov_b32 m0, 3072
    s_nop 0
    buffer_load_dwordx4 v11, s[16:19], s84 offen nt lds
    s_waitcnt vmcnt(19)
    s_mov_b32 m0, 68608
    s_nop 0
    buffer_load_dwordx4 v11, s[16:19], s86 offen nt lds
    s_waitcnt vmcnt(19)
    s_mov_b32 m0, 4096
    s_nop 0
    buffer_load_dwordx4 v12, s[16:19], s84 offen nt lds
    s_waitcnt vmcnt(19)
    s_mov_b32 m0, 69632
    s_nop 0
    buffer_load_dwordx4 v12, s[16:19], s86 offen nt lds
    s_waitcnt vmcnt(19)
    s_mov_b32 m0, 5120
    s_nop 0
    buffer_load_dwordx4 v13, s[16:19], s84 offen nt lds
    s_waitcnt vmcnt(19)
    s_mov_b32 m0, 70656
    s_nop 0
    buffer_load_dwordx4 v13, s[16:19], s86 offen nt lds
    s_waitcnt vmcnt(19)
    s_mov_b32 m0, 6144
    s_nop 0
    buffer_load_dwordx4 v14, s[16:19], s84 offen nt lds
    s_waitcnt vmcnt(19)
    s_mov_b32 m0, 71680
    s_nop 0
    buffer_load_dwordx4 v14, s[16:19], s86 offen nt lds
    s_waitcnt vmcnt(19)
    s_mov_b32 m0, 7168
    s_nop 0
    buffer_load_dwordx4 v15, s[16:19], s84 offen nt lds
    s_waitcnt vmcnt(19)
    s_mov_b32 m0, 72704
    s_nop 0
    buffer_load_dwordx4 v15, s[16:19], s86 offen nt lds
    s_waitcnt vmcnt(19)
    s_mov_b32 m0, 8192
    s_nop 0
    buffer_load_dwordx4 v8, s[16:19], s85 offen nt lds
    s_waitcnt vmcnt(19)
    s_mov_b32 m0, 73728
    s_nop 0
    buffer_load_dwordx4 v8, s[16:19], s87 offen nt lds
    s_waitcnt vmcnt(19)
    s_mov_b32 m0, 9216
    s_nop 0
    buffer_load_dwordx4 v9, s[16:19], s85 offen nt lds
    s_waitcnt vmcnt(19)
    s_mov_b32 m0, 74752
    s_nop 0
    buffer_load_dwordx4 v9, s[16:19], s87 offen nt lds
    s_barrier
    s_mov_b32 s80, s84
    s_mov_b32 s81, s85
    s_mov_b32 s82, s86
    s_mov_b32 s83, s87
    s_add_u32 s95, s95, 1
    v_readlane_b32 s60, v16, s95
    s_nop 3
    s_xor_b32 s84, s60, 0
    s_xor_b32 s85, s60, 16384
    s_xor_b32 s86, s60, 65536
    s_xor_b32 s87, s60, 81920
    s_waitcnt vmcnt(19)
    s_mov_b32 m0, 10240
    s_nop 0
    buffer_load_dwordx4 v10, s[16:19], s81 offen nt lds
    s_waitcnt vmcnt(19)
    s_mov_b32 m0, 75776
    s_nop 0
    buffer_load_dwordx4 v10, s[16:19], s83 offen nt lds
    s_waitcnt vmcnt(19)
    s_mov_b32 m0, 11264
    s_nop 0
    buffer_load_dwordx4 v11, s[16:19], s81 offen nt lds
    s_waitcnt vmcnt(19)
    s_mov_b32 m0, 76800
    s_nop 0
    buffer_load_dwordx4 v11, s[16:19], s83 offen nt lds
    s_waitcnt vmcnt(19)
    s_mov_b32 m0, 12288
    s_nop 0
    buffer_load_dwordx4 v12, s[16:19], s81 offen nt lds
    s_waitcnt vmcnt(19)
    s_mov_b32 m0, 77824
    s_nop 0
    buffer_load_dwordx4 v12, s[16:19], s83 offen nt lds
    s_waitcnt vmcnt(19)
    s_mov_b32 m0, 13312
    s_nop 0
    buffer_load_dwordx4 v13, s[16:19], s81 offen nt lds
    s_waitcnt vmcnt(19)
    s_mov_b32 m0, 78848
    s_nop 0
    buffer_load_dwordx4 v13, s[16:19], s83 offen nt lds
    s_waitcnt vmcnt(19)
    s_mov_b32 m0, 14336
    s_nop 0
    buffer_load_dwordx4 v14, s[16:19], s81 offen nt lds
    s_waitcnt vmcnt(19)
    s_mov_b32 m0, 79872
    s_nop 0
    buffer_load_dwordx4 v14, s[16:19], s83 offen nt lds
    s_waitcnt vmcnt(19)
    s_mov_b32 m0, 15360
    s_nop 0
    buffer_load_dwordx4 v15, s[16:19], s81 offen nt lds
    s_waitcnt vmcnt(19)
    s_mov_b32 m0, 80896
    s_nop 0
    buffer_load_dwordx4 v15, s[16:19], s83 offen nt lds
    s_waitcnt vmcnt(19)
    s_mov_b32 m0, 16384
    s_nop 0
    buffer_load_dwordx4 v8, s[20:23], s80 offen nt lds
    s_waitcnt vmcnt(19)
    s_mov_b32 m0, 81920
    s_nop 0
    buffer_load_dwordx4 v8, s[20:23], s82 offen nt lds
    s_waitcnt vmcnt(19)
    s_mov_b32 m0, 17408
    s_nop 0
    buffer_load_dwordx4 v9, s[20:23], s80 offen nt lds
    s_waitcnt vmcnt(19)
    s_mov_b32 m0, 82944
    s_nop 0
    buffer_load_dwordx4 v9, s[20:23], s82 offen nt lds
    s_waitcnt vmcnt(19)
    s_mov_b32 m0, 18432
    s_nop 0
    buffer_load_dwordx4 v10, s[20:23], s80 offen nt lds
    s_waitcnt vmcnt(19)
    s_mov_b32 m0, 83968
    s_nop 0
    buffer_load_dwordx4 v10, s[20:23], s82 offen nt lds
    s_waitcnt vmcnt(19)
    s_mov_b32 m0, 19456
    s_nop 0
    buffer_load_dwordx4 v11, s[20:23], s80 offen nt lds
    s_waitcnt vmcnt(19)
    s_mov_b32 m0, 84992
    s_nop 0
    buffer_load_dwordx4 v11, s[20:23], s82 offen nt lds
    s_waitcnt vmcnt(19)
    s_mov_b32 m0, 20480
    s_nop 0
    buffer_load_dwordx4 v12, s[20:23], s80 offen nt lds
    s_waitcnt vmcnt(19)
    s_mov_b32 m0, 86016
    s_nop 0
    buffer_load_dwordx4 v12, s[20:23], s82 offen nt lds
    s_waitcnt vmcnt(19)
    s_mov_b32 m0, 21504
    s_nop 0
    buffer_load_dwordx4 v13, s[20:23], s80 offen nt lds
    s_waitcnt vmcnt(19)
    s_mov_b32 m0, 87040
    s_nop 0
    buffer_load_dwordx4 v13, s[20:23], s82 offen nt lds
    s_waitcnt vmcnt(19)
    s_mov_b32 m0, 22528
    s_nop 0
    buffer_load_dwordx4 v14, s[20:23], s80 offen nt lds
    s_waitcnt vmcnt(19)
    s_mov_b32 m0, 88064
    s_nop 0
    buffer_load_dwordx4 v14, s[20:23], s82 offen nt lds
    s_waitcnt vmcnt(19)
    s_mov_b32 m0, 23552
    s_nop 0
    buffer_load_dwordx4 v15, s[20:23], s80 offen nt lds
    s_waitcnt vmcnt(19)
    s_mov_b32 m0, 89088
    s_nop 0
    buffer_load_dwordx4 v15, s[20:23], s82 offen nt lds
    s_waitcnt vmcnt(19)
    s_mov_b32 m0, 24576
    s_nop 0
    buffer_load_dwordx4 v8, s[20:23], s81 offen nt lds
    s_waitcnt vmcnt(19)
    s_mov_b32 m0, 90112
    s_nop 0
    buffer_load_dwordx4 v8, s[20:23], s83 offen nt lds
    s_waitcnt vmcnt(19)
    s_mov_b32 m0, 25600
    s_nop 0
    buffer_load_dwordx4 v9, s[20:23], s81 offen nt lds
    s_waitcnt vmcnt(19)
    s_mov_b32 m0, 91136
    s_nop 0
    buffer_load_dwordx4 v9, s[20:23], s83 offen nt lds
    s_barrier
    s_waitcnt vmcnt(19)
    s_mov_b32 m0, 26624
    s_nop 0
    buffer_load_dwordx4 v10, s[20:23], s81 offen nt lds
    s_waitcnt vmcnt(19)
    s_mov_b32 m0, 92160
    s_nop 0
    buffer_load_dwordx4 v10, s[20:23], s83 offen nt lds
    s_waitcnt vmcnt(19)
    s_mov_b32 m0, 27648
    s_nop 0
    buffer_load_dwordx4 v11, s[20:23], s81 offen nt lds
    s_waitcnt vmcnt(19)
    s_mov_b32 m0, 93184
    s_nop 0
    buffer_load_dwordx4 v11, s[20:23], s83 offen nt lds
    s_waitcnt vmcnt(19)
    s_mov_b32 m0, 28672
    s_nop 0
    buffer_load_dwordx4 v12, s[20:23], s81 offen nt lds
    s_waitcnt vmcnt(19)
    s_mov_b32 m0, 94208
    s_nop 0
    buffer_load_dwordx4 v12, s[20:23], s83 offen nt lds
    s_waitcnt vmcnt(19)
    s_mov_b32 m0, 29696
    s_nop 0
    buffer_load_dwordx4 v13, s[20:23], s81 offen nt lds
    s_waitcnt vmcnt(19)
    s_mov_b32 m0, 95232
    s_nop 0
    buffer_load_dwordx4 v13, s[20:23], s83 offen nt lds
    s_waitcnt vmcnt(19)
    s_mov_b32 m0, 30720
    s_nop 0
    buffer_load_dwordx4 v14, s[20:23], s81 offen nt lds
    s_waitcnt vmcnt(19)
    s_mov_b32 m0, 96256
    s_nop 0
    buffer_load_dwordx4 v14, s[20:23], s83 offen nt lds
    s_waitcnt vmcnt(19)
    s_mov_b32 m0, 31744
    s_nop 0
    buffer_load_dwordx4 v15, s[20:23], s81 offen nt lds
    s_waitcnt vmcnt(19)
    s_mov_b32 m0, 97280
    s_nop 0
    buffer_load_dwordx4 v15, s[20:23], s83 offen nt lds
    s_waitcnt vmcnt(19)
    s_mov_b32 m0, 32768
    s_nop 0
    buffer_load_dwordx4 v8, s[16:19], s84 offen nt lds
    s_waitcnt vmcnt(19)
    s_mov_b32 m0, 98304
    s_nop 0
    buffer_load_dwordx4 v8, s[16:19], s86 offen nt lds
    s_waitcnt vmcnt(19)
    s_mov_b32 m0, 33792
    s_nop 0
    buffer_load_dwordx4 v9, s[16:19], s84 offen nt lds
    s_waitcnt vmcnt(19)
    s_mov_b32 m0, 99328
    s_nop 0
    buffer_load_dwordx4 v9, s[16:19], s86 offen nt lds
    s_waitcnt vmcnt(19)
    s_mov_b32 m0, 34816
    s_nop 0
    buffer_load_dwordx4 v10, s[16:19], s84 offen nt lds
    s_waitcnt vmcnt(19)
    s_mov_b32 m0, 100352
    s_nop 0
    buffer_load_dwordx4 v10, s[16:19], s86 offen nt lds
    s_waitcnt vmcnt(19)
    s_mov_b32 m0, 35840
    s_nop 0
    buffer_load_dwordx4 v11, s[16:19], s84 offen nt lds
    s_waitcnt vmcnt(19)
    s_mov_b32 m0, 101376
    s_nop 0
    buffer_load_dwordx4 v11, s[16:19], s86 offen nt lds
    s_waitcnt vmcnt(19)
    s_mov_b32 m0, 36864
    s_nop 0
    buffer_load_dwordx4 v12, s[16:19], s84 offen nt lds
    s_waitcnt vmcnt(19)
    s_mov_b32 m0, 102400
    s_nop 0
    buffer_load_dwordx4 v12, s[16:19], s86 offen nt lds
    s_waitcnt vmcnt(19)
    s_mov_b32 m0, 37888
    s_nop 0
    buffer_load_dwordx4 v13, s[16:19], s84 offen nt lds
    s_waitcnt vmcnt(19)
    s_mov_b32 m0, 103424
    s_nop 0
    buffer_load_dwordx4 v13, s[16:19], s86 offen nt lds
    s_waitcnt vmcnt(19)
    s_mov_b32 m0, 38912
    s_nop 0
    buffer_load_dwordx4 v14, s[16:19], s84 offen nt lds
    s_waitcnt vmcnt(19)
    s_mov_b32 m0, 104448
    s_nop 0
    buffer_load_dwordx4 v14, s[16:19], s86 offen nt lds
    s_waitcnt vmcnt(19)
    s_mov_b32 m0, 39936
    s_nop 0
    buffer_load_dwordx4 v15, s[16:19], s84 offen nt lds
    s_waitcnt vmcnt(19)
    s_mov_b32 m0, 105472
    s_nop 0
    buffer_load_dwordx4 v15, s[16:19], s86 offen nt lds
    s_waitcnt vmcnt(19)
    s_mov_b32 m0, 40960
    s_nop 0
    buffer_load_dwordx4 v8, s[16:19], s85 offen nt lds
    s_waitcnt vmcnt(19)
    s_mov_b32 m0, 106496
    s_nop 0
    buffer_load_dwordx4 v8, s[16:19], s87 offen nt lds
    s_waitcnt vmcnt(19)
    s_mov_b32 m0, 41984
    s_nop 0
    buffer_load_dwordx4 v9, s[16:19], s85 offen nt lds
    s_waitcnt vmcnt(19)
    s_mov_b32 m0, 107520
    s_nop 0
    buffer_load_dwordx4 v9, s[16:19], s87 offen nt lds
    s_barrier
    s_mov_b32 s80, s84
    s_mov_b32 s81, s85
    s_mov_b32 s82, s86
    s_mov_b32 s83, s87
    s_add_u32 s95, s95, 1
    v_readlane_b32 s60, v16, s95
    s_nop 3
    s_xor_b32 s84, s60, 0
    s_xor_b32 s85, s60, 16384
    s_xor_b32 s86, s60, 65536
    s_xor_b32 s87, s60, 81920
    s_sub_u32 s53, s53, 1
    s_cmp_lg_u32 s53, 0
    s_cbranch_scc1 L_lloop
L_llast:
    s_waitcnt vmcnt(19)
    s_mov_b32 m0, 43008
    s_nop 0
    buffer_load_dwordx4 v10, s[16:19], s81 offen nt lds
    s_waitcnt vmcnt(19)
    s_mov_b32 m0, 108544
    s_nop 0
    buffer_load_dwordx4 v10, s[16:19], s83 offen nt lds
    s_waitcnt vmcnt(19)
    s_mov_b32 m0, 44032
    s_nop 0
    buffer_load_dwordx4 v11, s[16:19], s81 offen nt lds
    s_waitcnt vmcnt(19)
    s_mov_b32 m0, 109568
    s_nop 0
    buffer_load_dwordx4 v11, s[16:19], s83 offen nt lds
    s_waitcnt vmcnt(19)
    s_mov_b32 m0, 45056
    s_nop 0
    buffer_load_dwordx4 v12, s[16:19], s81 offen nt lds
    s_waitcnt vmcnt(19)
    s_mov_b32 m0, 110592
    s_nop 0
    buffer_load_dwordx4 v12, s[16:19], s83 offen nt lds
    s_waitcnt vmcnt(19)
    s_mov_b32 m0, 46080
    s_nop 0
    buffer_load_dwordx4 v13, s[16:19], s81 offen nt lds
    s_waitcnt vmcnt(19)
    s_mov_b32 m0, 111616
    s_nop 0
    buffer_load_dwordx4 v13, s[16:19], s83 offen nt lds
    s_waitcnt vmcnt(19)
    s_mov_b32 m0, 47104
    s_nop 0
    buffer_load_dwordx4 v14, s[16:19], s81 offen nt lds
    s_waitcnt vmcnt(19)
    s_mov_b32 m0, 112640
    s_nop 0
    buffer_load_dwordx4 v14, s[16:19], s83 offen nt lds
    s_waitcnt vmcnt(19)
    s_mov_b32 m0, 48128
    s_nop 0
    buffer_load_dwordx4 v15, s[16:19], s81 offen nt lds
    s_waitcnt vmcnt(19)
    s_mov_b32 m0, 113664
    s_nop 0
    buffer_load_dwordx4 v15, s[16:19], s83 offen nt lds
    s_waitcnt vmcnt(19)
    s_mov_b32 m0, 49152
    s_nop 0
    buffer_load_dwordx4 v8, s[20:23], s80 offen nt lds
    s_waitcnt vmcnt(19)
    s_mov_b32 m0, 114688
    s_nop 0
    buffer_load_dwordx4 v8, s[20:23], s82 offen nt lds
    s_waitcnt vmcnt(19)
    s_mov_b32 m0, 50176
    s_nop 0
    buffer_load_dwordx4 v9, s[20:23], s80 offen nt lds
    s_waitcnt vmcnt(19)
    s_mov_b32 m0, 115712
    s_nop 0
    buffer_load_dwordx4 v9, s[20:23], s82 offen nt lds
    s_waitcnt vmcnt(19)
    s_mov_b32 m0, 51200
    s_nop 0
    buffer_load_dwordx4 v10, s[20:23], s80 offen nt lds
    s_waitcnt vmcnt(19)
    s_mov_b32 m0, 116736
    s_nop 0
    buffer_load_dwordx4 v10, s[20:23], s82 offen nt lds
    s_waitcnt vmcnt(19)
    s_mov_b32 m0, 52224
    s_nop 0
    buffer_load_dwordx4 v11, s[20:23], s80 offen nt lds
    s_waitcnt vmcnt(19)
    s_mov_b32 m0, 117760
    s_nop 0
    buffer_load_dwordx4 v11, s[20:23], s82 offen nt lds
    s_waitcnt vmcnt(19)
    s_mov_b32 m0, 53248
    s_nop 0
    buffer_load_dwordx4 v12, s[20:23], s80 offen nt lds
    s_waitcnt vmcnt(19)
    s_mov_b32 m0, 118784
    s_nop 0
    buffer_load_dwordx4 v12, s[20:23], s82 offen nt lds
    s_waitcnt vmcnt(19)
    s_mov_b32 m0, 54272
    s_nop 0
    buffer_load_dwordx4 v13, s[20:23], s80 offen nt lds
    s_waitcnt vmcnt(19)
    s_mov_b32 m0, 119808
    s_nop 0
    buffer_load_dwordx4 v13, s[20:23], s82 offen nt lds
    s_waitcnt vmcnt(19)
    s_mov_b32 m0, 55296
    s_nop 0
    buffer_load_dwordx4 v14, s[20:23], s80 offen nt lds
    s_waitcnt vmcnt(19)
    s_mov_b32 m0, 120832
    s_nop 0
    buffer_load_dwordx4 v14, s[20:23], s82 offen nt lds
    s_waitcnt vmcnt(19)
    s_mov_b32 m0, 56320
    s_nop 0
    buffer_load_dwordx4 v15, s[20:23], s80 offen nt lds
    s_waitcnt lgkmcnt(0)
    s_and_b32 s56, s56, 1
    s_and_b32 s57, s57, 1
    s_lshl1_add_u32 s54, s57, s56
    s_lshl1_add_u32 s35, s29, 16
    s_lshl_b32 s54, s54, s35
    s_or_b32 s54, s54, 1
    s_atomic_add s54, s[58:59], 0 glc
    s_waitcnt vmcnt(19)
    s_mov_b32 m0, 121856
    s_nop 0
    buffer_load_dwordx4 v15, s[20:23], s82 offen nt lds
    s_waitcnt vmcnt(19)
    s_mov_b32 m0, 57344
    s_nop 0
    buffer_load_dwordx4 v8, s[20:23], s81 offen nt lds
    s_waitcnt vmcnt(19)
    s_mov_b32 m0, 122880
    s_nop 0
    buffer_load_dwordx4 v8, s[20:23], s83 offen nt lds
    s_waitcnt vmcnt(19)
    s_mov_b32 m0, 58368
    s_nop 0
    buffer_load_dwordx4 v9, s[20:23], s81 offen nt lds
    s_waitcnt vmcnt(19)
    s_mov_b32 m0, 123904
    s_nop 0
    buffer_load_dwordx4 v9, s[20:23], s83 offen nt lds
    s_barrier
    s_waitcnt vmcnt(19)
    s_mov_b32 m0, 59392
    s_nop 0
    buffer_load_dwordx4 v10, s[20:23], s81 offen nt lds
    s_waitcnt vmcnt(19)
    s_mov_b32 m0, 124928
    s_nop 0
    buffer_load_dwordx4 v10, s[20:23], s83 offen nt lds
    s_waitcnt vmcnt(19)
    s_mov_b32 m0, 60416
    s_nop 0
    buffer_load_dwordx4 v11, s[20:23], s81 offen nt lds
    s_waitcnt vmcnt(19)
    s_mov_b32 m0, 125952
    s_nop 0
    buffer_load_dwordx4 v11, s[20:23], s83 offen nt lds
    s_waitcnt vmcnt(19)
    s_mov_b32 m0, 61440
    s_nop 0
    buffer_load_dwordx4 v12, s[20:23], s81 offen nt lds
    s_waitcnt vmcnt(19)
    s_mov_b32 m0, 126976
    s_nop 0
    buffer_load_dwordx4 v12, s[20:23], s83 offen nt lds
    s_waitcnt vmcnt(19)
    s_mov_b32 m0, 62464
    s_nop 0
    buffer_load_dwordx4 v13, s[20:23], s81 offen nt lds
    s_waitcnt vmcnt(19)
    s_mov_b32 m0, 128000
    s_nop 0
    buffer_load_dwordx4 v13, s[20:23], s83 offen nt lds
    s_waitcnt vmcnt(19)
    s_mov_b32 m0, 63488
    s_nop 0
    buffer_load_dwordx4 v14, s[20:23], s81 offen nt lds
    s_waitcnt vmcnt(19)
    s_mov_b32 m0, 129024
    s_nop 0
    buffer_load_dwordx4 v14, s[20:23], s83 offen nt lds
    s_waitcnt vmcnt(19)
    s_mov_b32 m0, 64512
    s_nop 0
    buffer_load_dwordx4 v15, s[20:23], s81 offen nt lds
    s_waitcnt vmcnt(19)
    s_mov_b32 m0, 130048
    s_nop 0
    buffer_load_dwordx4 v15, s[20:23], s83 offen nt lds
    s_waitcnt lgkmcnt(0)
    s_and_b32 s35, s54, 0xff
    s_cmp_lg_u32 s35, 3
    s_cbranch_scc1 L_nofl
    s_load_dwordx2 s[64:65], s[48:49], 0 glc
    s_load_dwordx2 s[68:69], s[48:49], 128 glc
    s_load_dwordx2 s[72:73], s[48:49], 256 glc
    s_load_dwordx2 s[76:77], s[48:49], 384 glc
L_nofl:
    s_barrier
    s_waitcnt lgkmcnt(0)
    s_cmp_lg_u32 s35, 3
    s_cbranch_scc1 L_tkdone
    s_mov_b32 s63, 0
    s_and_b32 s64, s64, 1
    s_and_b32 s65, s65, 1
    s_lshl1_add_u32 s55, s65, s64
    s_lshl_b32 s55, s55, 16
    s_or_b32 s63, s63, s55
    s_and_b32 s68, s68, 1
    s_and_b32 s69, s69, 1
    s_lshl1_add_u32 s55, s69, s68
    s_lshl_b32 s55, s55, 18
    s_or_b32 s63, s63, s55
    s_and_b32 s72, s72, 1
    s_and_b32 s73, s73, 1
    s_lshl1_add_u32 s55, s73, s72
    s_lshl_b32 s55, s55, 20
    s_or_b32 s63, s63, s55
    s_and_b32 s76, s76, 1
    s_and_b32 s77, s77, 1
    s_lshl1_add_u32 s55, s77, s76
    s_lshl_b32 s55, s55, 22
    s_or_b32 s63, s63, s55
    s_xor_b32 s63, s63, s54
    s_lshl_b32 s55, s29, 1
    s_lshl_b32 s55, 0x30000, s55
    s_or_b32 s63, s63, s55
    s_and_b32 s63, s63, 0xff0000
    s_cmp_lg_u32 s63, 0xff0000
    s_cbranch_scc1 L_tkdone
    s_or_b32 s54, s54, 0x100
L_tkdone:
    v_mov_b32 v5, s54
    ds_write_b32 v4, v5
    s_waitcnt vmcnt(0) lgkmcnt(0)
    s_barrier
    s_endpgm
L_consumer:
    s_mov_b32 s30, s3
    s_mul_i32 s55, s30, 2176
    v_lshl_or_b32 v4, v2, 12, v1
    v_xor_b32 v4, s55, v4
    s_lshl_b32 s54, s30, 12
    s_lshl_b32 s63, s28, 13
    s_lshl_b32 s52, s30, 16
    s_waitcnt lgkmcnt(0)
    s_add_u32 s24, s4, s63
    s_addc_u32 s25, s5, 0
    s_and_b32 s25, s25, 0xffff
    s_mov_b32 s26, 0x2000
    s_mov_b32 s27, 0x20000
    s_add_u32 m0, s54, 135168
    s_nop 0
    buffer_load_dwordx4 v4, s[24:27], 0 offen lds
    v_xor_b32 v5, 0x220, v4
    s_add_u32 m0, s54, 136192
    s_nop 0
    buffer_load_dwordx4 v5, s[24:27], 0 offen lds
    v_xor_b32 v5, 0x440, v4
    s_add_u32 m0, s54, 137216
    s_nop 0
    buffer_load_dwordx4 v5, s[24:27], 0 offen lds
    v_xor_b32 v5, 0x660, v4
    s_add_u32 m0, s54, 138240
    s_nop 0
    buffer_load_dwordx4 v5, s[24:27], 0 offen lds
    s_add_u32 s58, s12, s35
    s_addc_u32 s59, s13, 0
    s_add_u32 s40, s10, s63
    s_addc_u32 s41, s11, 0
    s_and_b32 s41, s41, 0xffff
    s_mov_b32 s42, 0x2000
    s_mov_b32 s43, 0x20000
    s_mov_b32 s36, s14
    s_and_b32 s37, s15, 0xffff
    s_mov_b32 s38, 0x480000
    s_mov_b32 s39, 0x20000
    s_lshl_b32 s55, s28, 9
    s_add_u32 s55, s55, 0x500000
    s_add_u32 s48, s14, s55
    s_addc_u32 s49, s15, 0
    s_lshl_b32 s55, s29, 7
    s_add_u32 s50, s48, s55
    s_addc_u32 s51, s49, 0
    s_lshl_b32 s63, s30, 2
    s_add_u32 s50, s50, s63
    s_addc_u32 s51, s51, 0
    s_load_dword s56, s[50:51], 0 glc
    v_lshlrev_b32 v255, 7, v0
    v_add_u32 v255, s63, v255
    s_lshl_b32 s32, 1, s29
    s_mov_b32 s33, 0
    s_mov_b32 s34, 0x3db8aa3b
    v_and_b32 v10, 15, v0
    v_lshrrev_b32 v11, 4, v0
    v_and_b32 v12, 7, v10
    v_lshlrev_b32 v13, 1, v12
    v_xor_b32 v13, v13, v11
    v_lshlrev_b32 v13, 4, v13
    v_lshl_or_b32 v13, v12, 10, v13
    v_lshrrev_b32 v12, 3, v10
    v_lshl_or_b32 v13, v12, 9, v13
    v_add_u32 v14, 135168, v13
    v_add_u32 v13, s52, v13
    v_xor_b32 v216, 0, v13
    v_xor_b32 v217, 64, v13
    v_xor_b32 v218, 128, v13
    v_xor_b32 v219, 192, v13
    v_xor_b32 v20, 0, v14
    v_xor_b32 v21, 64, v14
    v_xor_b32 v22, 128, v14
    v_xor_b32 v23, 192, v14
    v_and_b32 v12, 1, v11
    v_lshrrev_b32 v13, 2, v10
    v_lshl_or_b32 v12, v12, 2, v13
    v_bfe_u32 v13, v10, 1, 1
    v_lshlrev_b32 v14, 1, v12
    v_xor_b32 v13, v13, v14
    v_lshlrev_b32 v13, 4, v13
    v_lshl_or_b32 v13, v12, 10, v13
    v_lshrrev_b32 v12, 1, v11
    v_lshl_or_b32 v13, v12, 9, v13
    v_and_b32 v12, 1, v10
    v_lshl_or_b32 v13, v12, 3, v13
    v_add_u32 v13, s52, v13
    s_lshl_b32 s62, s30, 8
    v_xor_b32 v13, s62, v13
    v_xor_b32 v220, 0, v13
    v_xor_b32 v221, 32, v13
    v_xor_b32 v222, 64, v13
    v_xor_b32 v223, 96, v13
    v_xor_b32 v224, 128, v13
    v_xor_b32 v225, 160, v13
    v_xor_b32 v226, 192, v13
    v_xor_b32 v227, 224, v13
    v_xor_b32 v228, 256, v13
    v_xor_b32 v229, 288, v13
    v_xor_b32 v230, 320, v13
    v_xor_b32 v231, 352, v13
    v_xor_b32 v232, 384, v13
    v_xor_b32 v233, 416, v13
    v_xor_b32 v234, 448, v13
    v_xor_b32 v235, 480, v13
    v_mov_b32 v1, 0
    v_mov_b32 v254, 132096
    v_mov_b32 v6, 0xff800000
    v_mov_b32 v7, 0
    v_mov_b32 v24, 0
    v_mov_b32 v25, 0
    v_mov_b32 v26, 0
    v_mov_b32 v27, 0
    v_mov_b32 v28, 0
    v_mov_b32 v29, 0
    v_mov_b32 v30, 0
    v_mov_b32 v31, 0
    v_mov_b32 v32, 0
    v_mov_b32 v33, 0
    v_mov_b32 v34, 0
    v_mov_b32 v35, 0
    v_mov_b32 v36, 0
    v_mov_b32 v37, 0
    v_mov_b32 v38, 0
    v_mov_b32 v39, 0
    v_mov_b32 v40, 0
    v_mov_b32 v41, 0
    v_mov_b32 v42, 0
    v_mov_b32 v43, 0
    v_mov_b32 v44, 0
    v_mov_b32 v45, 0
    v_mov_b32 v46, 0
    v_mov_b32 v47, 0
    v_mov_b32 v48, 0
    v_mov_b32 v49, 0
    v_mov_b32 v50, 0
    v_mov_b32 v51, 0
    v_mov_b32 v52, 0
    v_mov_b32 v53, 0
    v_mov_b32 v54, 0
    v_mov_b32 v55, 0
    v_mov_b32 v56, 0
    v_mov_b32 v57, 0
    v_mov_b32 v58, 0
    v_mov_b32 v59, 0
    v_mov_b32 v60, 0
    v_mov_b32 v61, 0
    v_mov_b32 v62, 0
    v_mov_b32 v63, 0
    v_mov_b32 v64, 0
    v_mov_b32 v65, 0
    v_mov_b32 v66, 0
    v_mov_b32 v67, 0
    v_mov_b32 v68, 0
    v_mov_b32 v69, 0
    v_mov_b32 v70, 0
    v_mov_b32 v71, 0
    v_mov_b32 v72, 0
    v_mov_b32 v73, 0
    v_mov_b32 v74, 0
    v_mov_b32 v75, 0
    v_mov_b32 v76, 0
    v_mov_b32 v77, 0
    v_mov_b32 v78, 0
    v_mov_b32 v79, 0
    v_mov_b32 v80, 0
    v_mov_b32 v81, 0
    v_mov_b32 v82, 0
    v_mov_b32 v83, 0
    v_mov_b32 v84, 0
    v_mov_b32 v85, 0
    v_mov_b32 v86, 0
    v_mov_b32 v87, 0
    v_lshlrev_b32 v238, 4, v0
    v_add_u32 v239, 4096, v238
    v_lshlrev_b32 v240, 3, v0
    v_add_u32 v236, s52, v238
    v_xor_b32 v237, 65536, v236
    s_lshl_b32 s35, s30, 9
    s_add_u32 s35, s35, 131072
    v_add_u32 v241, s35, v240
    v_xor_b32 v242, 512, v241
    v_lshlrev_b32 v243, 9, v10
    v_and_b32 v12, 1, v11
    v_lshl_or_b32 v243, v12, 5, v243
    v_lshrrev_b32 v12, 1, v11
    v_lshl_or_b32 v243, v12, 4, v243
    s_xor_b32 s35, s29, 0
    s_lshl_b32 s55, s28, 2
    s_add_u32 s35, s35, s55
    s_lshl_b32 s35, s35, 1
    s_add_u32 s35, s35, s30
    s_lshl_b32 s60, s35, 13
    s_lshl_b32 s61, s35, 9
    s_add_u32 s61, s61, 0x400000
    s_xor_b32 s35, s29, 1
    s_lshl_b32 s55, s28, 2
    s_add_u32 s35, s35, s55
    s_lshl_b32 s35, s35, 1
    s_add_u32 s35, s35, s30
    s_lshl_b32 s88, s35, 13
    s_lshl_b32 s91, s35, 9
    s_add_u32 s91, s91, 0x400000
    s_andn2_b32 s35, 2, s29
    s_or_b32 s35, s35, 0
    s_lshl_b32 s55, s28, 2
    s_add_u32 s35, s35, s55
    s_lshl_b32 s35, s35, 1
    s_add_u32 s35, s35, s30
    s_lshl_b32 s89, s35, 13
    s_lshl_b32 s92, s35, 9
    s_add_u32 s92, s92, 0x400000
    s_andn2_b32 s35, 2, s29
    s_or_b32 s35, s35, 1
    s_lshl_b32 s55, s28, 2
    s_add_u32 s35, s35, s55
    s_lshl_b32 s35, s35, 1
    s_add_u32 s35, s35, s30
    s_lshl_b32 s90, s35, 13
    s_lshl_b32 s93, s35, 9
    s_add_u32 s93, s93, 0x400000
    s_mov_b32 s53, 15
    s_waitcnt vmcnt(0)
    s_barrier
    ds_read_b128 a[64:67], v20 offset:0
    ds_read_b128 a[68:71], v21 offset:0
    ds_read_b128 a[72:75], v22 offset:0
    ds_read_b128 a[76:79], v23 offset:0
    ds_read_b128 a[80:83], v20 offset:256
    ds_read_b128 a[84:87], v21 offset:256
    ds_read_b128 a[88:91], v22 offset:256
    ds_read_b128 a[92:95], v23 offset:256
    s_waitcnt lgkmcnt(0)
    ds_read_b128 a[0:3], v216 offset:0
    ds_read_b128 a[4:7], v217 offset:0
    ds_read_b128 a[8:11], v218 offset:0
    ds_read_b128 a[12:15], v219 offset:0
    ds_read_b128 a[16:19], v216 offset:256
    ds_read_b128 a[20:23], v217 offset:256
    ds_read_b128 a[24:27], v218 offset:256
    ds_read_b128 a[28:31], v219 offset:256
    ds_read_b128 a[32:35], v216 offset:8192
    ds_read_b128 a[36:39], v217 offset:8192
    ds_read_b128 a[40:43], v218 offset:8192
    ds_read_b128 a[44:47], v219 offset:8192
    s_waitcnt lgkmcnt(8)
    v_mfma_f32_16x16x32_bf16 v[12:15], a[0:3], a[64:67], 0
    v_mfma_f32_16x16x32_bf16 v[12:15], a[4:7], a[68:71], v[12:15]
    v_mfma_f32_16x16x32_bf16 v[12:15], a[8:11], a[72:75], v[12:15]
    v_mfma_f32_16x16x32_bf16 v[12:15], a[12:15], a[76:79], v[12:15]
    ds_read_b128 a[48:51], v216 offset:8448
    ds_read_b128 a[52:55], v217 offset:8448
    ds_read_b128 a[56:59], v218 offset:8448
    ds_read_b128 a[60:63], v219 offset:8448
    s_waitcnt lgkmcnt(8)
    v_mfma_f32_16x16x32_bf16 v[12:15], a[16:19], a[80:83], v[12:15]
    v_mfma_f32_16x16x32_bf16 v[12:15], a[20:23], a[84:87], v[12:15]
    v_mfma_f32_16x16x32_bf16 v[12:15], a[24:27], a[88:91], v[12:15]
    v_mfma_f32_16x16x32_bf16 v[12:15], a[28:31], a[92:95], v[12:15]
    s_waitcnt lgkmcnt(4)
    v_mfma_f32_16x16x32_bf16 v[16:19], a[32:35], a[64:67], 0
    v_mfma_f32_16x16x32_bf16 v[16:19], a[36:39], a[68:71], v[16:19]
    v_mfma_f32_16x16x32_bf16 v[16:19], a[40:43], a[72:75], v[16:19]
    v_mfma_f32_16x16x32_bf16 v[16:19], a[44:47], a[76:79], v[16:19]
    s_waitcnt lgkmcnt(0)
    v_mfma_f32_16x16x32_bf16 v[16:19], a[48:51], a[80:83], v[16:19]
    v_mfma_f32_16x16x32_bf16 v[16:19], a[52:55], a[84:87], v[16:19]
    v_mfma_f32_16x16x32_bf16 v[16:19], a[56:59], a[88:91], v[16:19]
    v_mfma_f32_16x16x32_bf16 v[16:19], a[60:63], a[92:95], v[16:19]
    s_nop 7
    v_max3_f32 v10, v12, v13, v14
    v_max3_f32 v9, v16, v17, v18
    v_max3_f32 v10, v10, v15, v19
    v_max_f32 v10, v10, v9
    v_mov_b32 v9, v10
    s_nop 1
    v_permlane16_swap_b32 v10, v9
    s_nop 1
    v_max_f32 v10, v10, v9
    v_mov_b32 v9, v10
    s_nop 1
    v_permlane32_swap_b32 v10, v9
    s_nop 1
    v_max_f32 v10, v10, v9
    v_mul_f32 v10, s34, v10
    v_cmp_gt_f32 vcc, v10, v6
    s_cbranch_vccz L_nr_f
    v_max_f32 v9, v6, v10
    v_sub_f32 v8, v6, v9
    v_exp_f32 v8, v8
    v_mov_b32 v6, v9
    v_mul_f32 v7, v7, v8
    v_pk_mul_f32 v[24:25], v[8:9], v[24:25] op_sel:[0,0] op_sel_hi:[0,1]
    v_pk_mul_f32 v[26:27], v[8:9], v[26:27] op_sel:[0,0] op_sel_hi:[0,1]
    v_pk_mul_f32 v[28:29], v[8:9], v[28:29] op_sel:[0,0] op_sel_hi:[0,1]
    v_pk_mul_f32 v[30:31], v[8:9], v[30:31] op_sel:[0,0] op_sel_hi:[0,1]
    v_pk_mul_f32 v[32:33], v[8:9], v[32:33] op_sel:[0,0] op_sel_hi:[0,1]
    v_pk_mul_f32 v[34:35], v[8:9], v[34:35] op_sel:[0,0] op_sel_hi:[0,1]
    v_pk_mul_f32 v[36:37], v[8:9], v[36:37] op_sel:[0,0] op_sel_hi:[0,1]
    v_pk_mul_f32 v[38:39], v[8:9], v[38:39] op_sel:[0,0] op_sel_hi:[0,1]
    v_pk_mul_f32 v[40:41], v[8:9], v[40:41] op_sel:[0,0] op_sel_hi:[0,1]
    v_pk_mul_f32 v[42:43], v[8:9], v[42:43] op_sel:[0,0] op_sel_hi:[0,1]
    v_pk_mul_f32 v[44:45], v[8:9], v[44:45] op_sel:[0,0] op_sel_hi:[0,1]
    v_pk_mul_f32 v[46:47], v[8:9], v[46:47] op_sel:[0,0] op_sel_hi:[0,1]
    v_pk_mul_f32 v[48:49], v[8:9], v[48:49] op_sel:[0,0] op_sel_hi:[0,1]
    v_pk_mul_f32 v[50:51], v[8:9], v[50:51] op_sel:[0,0] op_sel_hi:[0,1]
    v_pk_mul_f32 v[52:53], v[8:9], v[52:53] op_sel:[0,0] op_sel_hi:[0,1]
    v_pk_mul_f32 v[54:55], v[8:9], v[54:55] op_sel:[0,0] op_sel_hi:[0,1]
    v_pk_mul_f32 v[56:57], v[8:9], v[56:57] op_sel:[0,0] op_sel_hi:[0,1]
    v_pk_mul_f32 v[58:59], v[8:9], v[58:59] op_sel:[0,0] op_sel_hi:[0,1]
    v_pk_mul_f32 v[60:61], v[8:9], v[60:61] op_sel:[0,0] op_sel_hi:[0,1]
    v_pk_mul_f32 v[62:63], v[8:9], v[62:63] op_sel:[0,0] op_sel_hi:[0,1]
    v_pk_mul_f32 v[64:65], v[8:9], v[64:65] op_sel:[0,0] op_sel_hi:[0,1]
    v_pk_mul_f32 v[66:67], v[8:9], v[66:67] op_sel:[0,0] op_sel_hi:[0,1]
    v_pk_mul_f32 v[68:69], v[8:9], v[68:69] op_sel:[0,0] op_sel_hi:[0,1]
    v_pk_mul_f32 v[70:71], v[8:9], v[70:71] op_sel:[0,0] op_sel_hi:[0,1]
    v_pk_mul_f32 v[72:73], v[8:9], v[72:73] op_sel:[0,0] op_sel_hi:[0,1]
    v_pk_mul_f32 v[74:75], v[8:9], v[74:75] op_sel:[0,0] op_sel_hi:[0,1]
    v_pk_mul_f32 v[76:77], v[8:9], v[76:77] op_sel:[0,0] op_sel_hi:[0,1]
    v_pk_mul_f32 v[78:79], v[8:9], v[78:79] op_sel:[0,0] op_sel_hi:[0,1]
    v_pk_mul_f32 v[80:81], v[8:9], v[80:81] op_sel:[0,0] op_sel_hi:[0,1]
    v_pk_mul_f32 v[82:83], v[8:9], v[82:83] op_sel:[0,0] op_sel_hi:[0,1]
    v_pk_mul_f32 v[84:85], v[8:9], v[84:85] op_sel:[0,0] op_sel_hi:[0,1]
    v_pk_mul_f32 v[86:87], v[8:9], v[86:87] op_sel:[0,0] op_sel_hi:[0,1]
L_nr_f:
    v_fma_f32 v12, v12, s34, -v6
    v_fma_f32 v13, v13, s34, -v6
    v_fma_f32 v14, v14, s34, -v6
    v_fma_f32 v15, v15, s34, -v6
    v_fma_f32 v16, v16, s34, -v6
    v_fma_f32 v17, v17, s34, -v6
    v_fma_f32 v18, v18, s34, -v6
    v_fma_f32 v19, v19, s34, -v6
    v_exp_f32 v12, v12
    v_exp_f32 v13, v13
    v_exp_f32 v14, v14
    v_exp_f32 v15, v15
    v_exp_f32 v16, v16
    v_exp_f32 v17, v17
    v_exp_f32 v18, v18
    v_exp_f32 v19, v19
    v_add_f32 v10, v12, v13
    v_add_f32 v9, v14, v15
    v_cvt_pk_bf16_f32 v20, v12, v13
    v_cvt_pk_bf16_f32 v21, v14, v15
    v_cvt_pk_bf16_f32 v22, v16, v17
    v_cvt_pk_bf16_f32 v23, v18, v19
    v_add_f32 v10, v10, v16
    v_add_f32 v9, v9, v17
    v_add_f32 v10, v10, v18
    v_add_f32 v9, v9, v19
    v_add_f32 v7, v7, v10
    v_add_f32 v7, v7, v9
    s_barrier
    ds_read_b64_tr_b16 v[88:89], v220 offset:16384
    ds_read_b64_tr_b16 v[90:91], v220 offset:24576
    ds_read_b64_tr_b16 v[92:93], v221 offset:16384
    ds_read_b64_tr_b16 v[94:95], v221 offset:24576
    ds_read_b64_tr_b16 v[96:97], v222 offset:16384
    ds_read_b64_tr_b16 v[98:99], v222 offset:24576
    ds_read_b64_tr_b16 v[100:101], v223 offset:16384
    ds_read_b64_tr_b16 v[102:103], v223 offset:24576
    ds_read_b64_tr_b16 v[104:105], v224 offset:16384
    ds_read_b64_tr_b16 v[106:107], v224 offset:24576
    s_waitcnt lgkmcnt(8)
    v_mfma_f32_16x16x32_bf16 v[24:27], v[88:91], v[20:23], v[24:27]
    ds_read_b64_tr_b16 v[108:109], v225 offset:16384
    ds_read_b64_tr_b16 v[110:111], v225 offset:24576
    s_waitcnt lgkmcnt(8)
    v_mfma_f32_16x16x32_bf16 v[28:31], v[92:95], v[20:23], v[28:31]
    ds_read_b64_tr_b16 v[112:113], v226 offset:16384
    ds_read_b64_tr_b16 v[114:115], v226 offset:24576
    s_waitcnt lgkmcnt(8)
    v_mfma_f32_16x16x32_bf16 v[32:35], v[96:99], v[20:23], v[32:35]
    ds_read_b64_tr_b16 v[116:117], v227 offset:16384
    ds_read_b64_tr_b16 v[118:119], v227 offset:24576
    s_waitcnt lgkmcnt(8)
    v_mfma_f32_16x16x32_bf16 v[36:39], v[100:103], v[20:23], v[36:39]
    ds_read_b64_tr_b16 v[88:89], v228 offset:16384
    ds_read_b64_tr_b16 v[90:91], v228 offset:24576
    s_waitcnt lgkmcnt(8)
    v_mfma_f32_16x16x32_bf16 v[40:43], v[104:107], v[20:23], v[40:43]
    ds_read_b64_tr_b16 v[92:93], v229 offset:16384
    ds_read_b64_tr_b16 v[94:95], v229 offset:24576
    s_waitcnt lgkmcnt(8)
    v_mfma_f32_16x16x32_bf16 v[44:47], v[108:111], v[20:23], v[44:47]
    ds_read_b64_tr_b16 v[96:97], v230 offset:16384
    ds_read_b64_tr_b16 v[98:99], v230 offset:24576
    s_waitcnt lgkmcnt(8)
    v_mfma_f32_16x16x32_bf16 v[48:51], v[112:115], v[20:23], v[48:51]
    ds_read_b64_tr_b16 v[100:101], v231 offset:16384
    ds_read_b64_tr_b16 v[102:103], v231 offset:24576
    s_waitcnt lgkmcnt(8)
    v_mfma_f32_16x16x32_bf16 v[52:55], v[116:119], v[20:23], v[52:55]
    ds_read_b64_tr_b16 v[104:105], v232 offset:16384
    ds_read_b64_tr_b16 v[106:107], v232 offset:24576
    s_waitcnt lgkmcnt(8)
    v_mfma_f32_16x16x32_bf16 v[56:59], v[88:91], v[20:23], v[56:59]
    ds_read_b64_tr_b16 v[108:109], v233 offset:16384
    ds_read_b64_tr_b16 v[110:111], v233 offset:24576
    s_waitcnt lgkmcnt(8)
    v_mfma_f32_16x16x32_bf16 v[60:63], v[92:95], v[20:23], v[60:63]
    ds_read_b64_tr_b16 v[112:113], v234 offset:16384
    ds_read_b64_tr_b16 v[114:115], v234 offset:24576
    s_waitcnt lgkmcnt(8)
    v_mfma_f32_16x16x32_bf16 v[64:67], v[96:99], v[20:23], v[64:67]
    ds_read_b64_tr_b16 v[116:117], v235 offset:16384
    ds_read_b64_tr_b16 v[118:119], v235 offset:24576
    s_waitcnt lgkmcnt(8)
    v_mfma_f32_16x16x32_bf16 v[68:71], v[100:103], v[20:23], v[68:71]
    s_waitcnt lgkmcnt(6)
    v_mfma_f32_16x16x32_bf16 v[72:75], v[104:107], v[20:23], v[72:75]
    s_waitcnt lgkmcnt(4)
    v_mfma_f32_16x16x32_bf16 v[76:79], v[108:111], v[20:23], v[76:79]
    s_waitcnt lgkmcnt(2)
    v_mfma_f32_16x16x32_bf16 v[80:83], v[112:115], v[20:23], v[80:83]
    s_waitcnt lgkmcnt(0)
    v_mfma_f32_16x16x32_bf16 v[84:87], v[116:119], v[20:23], v[84:87]
    s_cmp_eq_u32 s53, 0
    s_cbranch_scc1 L_clast
L_cloop:
    s_barrier
    ds_read_b128 a[0:3], v216 offset:32768
    ds_read_b128 a[4:7], v217 offset:32768
    ds_read_b128 a[8:11], v218 offset:32768
    ds_read_b128 a[12:15], v219 offset:32768
    ds_read_b128 a[16:19], v216 offset:33024
    ds_read_b128 a[20:23], v217 offset:33024
    ds_read_b128 a[24:27], v218 offset:33024
    ds_read_b128 a[28:31], v219 offset:33024
    ds_read_b128 a[32:35], v216 offset:40960
    ds_read_b128 a[36:39], v217 offset:40960
    ds_read_b128 a[40:43], v218 offset:40960
    ds_read_b128 a[44:47], v219 offset:40960
    s_waitcnt lgkmcnt(8)
    v_mfma_f32_16x16x32_bf16 v[12:15], a[0:3], a[64:67], 0
    v_mfma_f32_16x16x32_bf16 v[12:15], a[4:7], a[68:71], v[12:15]
    v_mfma_f32_16x16x32_bf16 v[12:15], a[8:11], a[72:75], v[12:15]
    v_mfma_f32_16x16x32_bf16 v[12:15], a[12:15], a[76:79], v[12:15]
    ds_read_b128 a[48:51], v216 offset:41216
    ds_read_b128 a[52:55], v217 offset:41216
    ds_read_b128 a[56:59], v218 offset:41216
    ds_read_b128 a[60:63], v219 offset:41216
    s_waitcnt lgkmcnt(8)
    v_mfma_f32_16x16x32_bf16 v[12:15], a[16:19], a[80:83], v[12:15]
    v_mfma_f32_16x16x32_bf16 v[12:15], a[20:23], a[84:87], v[12:15]
    v_mfma_f32_16x16x32_bf16 v[12:15], a[24:27], a[88:91], v[12:15]
    v_mfma_f32_16x16x32_bf16 v[12:15], a[28:31], a[92:95], v[12:15]
    s_waitcnt lgkmcnt(4)
    v_mfma_f32_16x16x32_bf16 v[16:19], a[32:35], a[64:67], 0
    v_mfma_f32_16x16x32_bf16 v[16:19], a[36:39], a[68:71], v[16:19]
    v_mfma_f32_16x16x32_bf16 v[16:19], a[40:43], a[72:75], v[16:19]
    v_mfma_f32_16x16x32_bf16 v[16:19], a[44:47], a[76:79], v[16:19]
    s_waitcnt lgkmcnt(0)
    v_mfma_f32_16x16x32_bf16 v[16:19], a[48:51], a[80:83], v[16:19]
    v_mfma_f32_16x16x32_bf16 v[16:19], a[52:55], a[84:87], v[16:19]
    v_mfma_f32_16x16x32_bf16 v[16:19], a[56:59], a[88:91], v[16:19]
    v_mfma_f32_16x16x32_bf16 v[16:19], a[60:63], a[92:95], v[16:19]
    s_nop 7
    v_max3_f32 v10, v12, v13, v14
    v_max3_f32 v9, v16, v17, v18
    v_max3_f32 v10, v10, v15, v19
    v_max_f32 v10, v10, v9
    v_mov_b32 v9, v10
    s_nop 1
    v_permlane16_swap_b32 v10, v9
    s_nop 1
    v_max_f32 v10, v10, v9
    v_mov_b32 v9, v10
    s_nop 1
    v_permlane32_swap_b32 v10, v9
    s_nop 1
    v_max_f32 v10, v10, v9
    v_mul_f32 v10, s34, v10
    v_cmp_gt_f32 vcc, v10, v6
    s_cbranch_vccz L_nr_a
    v_max_f32 v9, v6, v10
    v_sub_f32 v8, v6, v9
    v_exp_f32 v8, v8
    v_mov_b32 v6, v9
    v_mul_f32 v7, v7, v8
    v_pk_mul_f32 v[24:25], v[8:9], v[24:25] op_sel:[0,0] op_sel_hi:[0,1]
    v_pk_mul_f32 v[26:27], v[8:9], v[26:27] op_sel:[0,0] op_sel_hi:[0,1]
    v_pk_mul_f32 v[28:29], v[8:9], v[28:29] op_sel:[0,0] op_sel_hi:[0,1]
    v_pk_mul_f32 v[30:31], v[8:9], v[30:31] op_sel:[0,0] op_sel_hi:[0,1]
    v_pk_mul_f32 v[32:33], v[8:9], v[32:33] op_sel:[0,0] op_sel_hi:[0,1]
    v_pk_mul_f32 v[34:35], v[8:9], v[34:35] op_sel:[0,0] op_sel_hi:[0,1]
    v_pk_mul_f32 v[36:37], v[8:9], v[36:37] op_sel:[0,0] op_sel_hi:[0,1]
    v_pk_mul_f32 v[38:39], v[8:9], v[38:39] op_sel:[0,0] op_sel_hi:[0,1]
    v_pk_mul_f32 v[40:41], v[8:9], v[40:41] op_sel:[0,0] op_sel_hi:[0,1]
    v_pk_mul_f32 v[42:43], v[8:9], v[42:43] op_sel:[0,0] op_sel_hi:[0,1]
    v_pk_mul_f32 v[44:45], v[8:9], v[44:45] op_sel:[0,0] op_sel_hi:[0,1]
    v_pk_mul_f32 v[46:47], v[8:9], v[46:47] op_sel:[0,0] op_sel_hi:[0,1]
    v_pk_mul_f32 v[48:49], v[8:9], v[48:49] op_sel:[0,0] op_sel_hi:[0,1]
    v_pk_mul_f32 v[50:51], v[8:9], v[50:51] op_sel:[0,0] op_sel_hi:[0,1]
    v_pk_mul_f32 v[52:53], v[8:9], v[52:53] op_sel:[0,0] op_sel_hi:[0,1]
    v_pk_mul_f32 v[54:55], v[8:9], v[54:55] op_sel:[0,0] op_sel_hi:[0,1]
    v_pk_mul_f32 v[56:57], v[8:9], v[56:57] op_sel:[0,0] op_sel_hi:[0,1]
    v_pk_mul_f32 v[58:59], v[8:9], v[58:59] op_sel:[0,0] op_sel_hi:[0,1]
    v_pk_mul_f32 v[60:61], v[8:9], v[60:61] op_sel:[0,0] op_sel_hi:[0,1]
    v_pk_mul_f32 v[62:63], v[8:9], v[62:63] op_sel:[0,0] op_sel_hi:[0,1]
    v_pk_mul_f32 v[64:65], v[8:9], v[64:65] op_sel:[0,0] op_sel_hi:[0,1]
    v_pk_mul_f32 v[66:67], v[8:9], v[66:67] op_sel:[0,0] op_sel_hi:[0,1]
    v_pk_mul_f32 v[68:69], v[8:9], v[68:69] op_sel:[0,0] op_sel_hi:[0,1]
    v_pk_mul_f32 v[70:71], v[8:9], v[70:71] op_sel:[0,0] op_sel_hi:[0,1]
    v_pk_mul_f32 v[72:73], v[8:9], v[72:73] op_sel:[0,0] op_sel_hi:[0,1]
    v_pk_mul_f32 v[74:75], v[8:9], v[74:75] op_sel:[0,0] op_sel_hi:[0,1]
    v_pk_mul_f32 v[76:77], v[8:9], v[76:77] op_sel:[0,0] op_sel_hi:[0,1]
    v_pk_mul_f32 v[78:79], v[8:9], v[78:79] op_sel:[0,0] op_sel_hi:[0,1]
    v_pk_mul_f32 v[80:81], v[8:9], v[80:81] op_sel:[0,0] op_sel_hi:[0,1]
    v_pk_mul_f32 v[82:83], v[8:9], v[82:83] op_sel:[0,0] op_sel_hi:[0,1]
    v_pk_mul_f32 v[84:85], v[8:9], v[84:85] op_sel:[0,0] op_sel_hi:[0,1]
    v_pk_mul_f32 v[86:87], v[8:9], v[86:87] op_sel:[0,0] op_sel_hi:[0,1]
L_nr_a:
    v_fma_f32 v12, v12, s34, -v6
    v_fma_f32 v13, v13, s34, -v6
    v_fma_f32 v14, v14, s34, -v6
    v_fma_f32 v15, v15, s34, -v6
    v_fma_f32 v16, v16, s34, -v6
    v_fma_f32 v17, v17, s34, -v6
    v_fma_f32 v18, v18, s34, -v6
    v_fma_f32 v19, v19, s34, -v6
    v_exp_f32 v12, v12
    v_exp_f32 v13, v13
    v_exp_f32 v14, v14
    v_exp_f32 v15, v15
    v_exp_f32 v16, v16
    v_exp_f32 v17, v17
    v_exp_f32 v18, v18
    v_exp_f32 v19, v19
    v_add_f32 v10, v12, v13
    v_add_f32 v9, v14, v15
    v_cvt_pk_bf16_f32 v20, v12, v13
    v_cvt_pk_bf16_f32 v21, v14, v15
    v_cvt_pk_bf16_f32 v22, v16, v17
    v_cvt_pk_bf16_f32 v23, v18, v19
    v_add_f32 v10, v10, v16
    v_add_f32 v9, v9, v17
    v_add_f32 v10, v10, v18
    v_add_f32 v9, v9, v19
    v_add_f32 v7, v7, v10
    v_add_f32 v7, v7, v9
    s_barrier
    ds_read_b64_tr_b16 v[88:89], v220 offset:49152
    ds_read_b64_tr_b16 v[90:91], v220 offset:57344
    ds_read_b64_tr_b16 v[92:93], v221 offset:49152
    ds_read_b64_tr_b16 v[94:95], v221 offset:57344
    ds_read_b64_tr_b16 v[96:97], v222 offset:49152
    ds_read_b64_tr_b16 v[98:99], v222 offset:57344
    ds_read_b64_tr_b16 v[100:101], v223 offset:49152
    ds_read_b64_tr_b16 v[102:103], v223 offset:57344
    ds_read_b64_tr_b16 v[104:105], v224 offset:49152
    ds_read_b64_tr_b16 v[106:107], v224 offset:57344
    s_waitcnt lgkmcnt(8)
    v_mfma_f32_16x16x32_bf16 v[24:27], v[88:91], v[20:23], v[24:27]
    ds_read_b64_tr_b16 v[108:109], v225 offset:49152
    ds_read_b64_tr_b16 v[110:111], v225 offset:57344
    s_waitcnt lgkmcnt(8)
    v_mfma_f32_16x16x32_bf16 v[28:31], v[92:95], v[20:23], v[28:31]
    ds_read_b64_tr_b16 v[112:113], v226 offset:49152
    ds_read_b64_tr_b16 v[114:115], v226 offset:57344
    s_waitcnt lgkmcnt(8)
    v_mfma_f32_16x16x32_bf16 v[32:35], v[96:99], v[20:23], v[32:35]
    ds_read_b64_tr_b16 v[116:117], v227 offset:49152
    ds_read_b64_tr_b16 v[118:119], v227 offset:57344
    s_waitcnt lgkmcnt(8)
    v_mfma_f32_16x16x32_bf16 v[36:39], v[100:103], v[20:23], v[36:39]
    ds_read_b64_tr_b16 v[88:89], v228 offset:49152
    ds_read_b64_tr_b16 v[90:91], v228 offset:57344
    s_waitcnt lgkmcnt(8)
    v_mfma_f32_16x16x32_bf16 v[40:43], v[104:107], v[20:23], v[40:43]
    ds_read_b64_tr_b16 v[92:93], v229 offset:49152
    ds_read_b64_tr_b16 v[94:95], v229 offset:57344
    s_waitcnt lgkmcnt(8)
    v_mfma_f32_16x16x32_bf16 v[44:47], v[108:111], v[20:23], v[44:47]
    ds_read_b64_tr_b16 v[96:97], v230 offset:49152
    ds_read_b64_tr_b16 v[98:99], v230 offset:57344
    s_waitcnt lgkmcnt(8)
    v_mfma_f32_16x16x32_bf16 v[48:51], v[112:115], v[20:23], v[48:51]
    ds_read_b64_tr_b16 v[100:101], v231 offset:49152
    ds_read_b64_tr_b16 v[102:103], v231 offset:57344
    s_waitcnt lgkmcnt(8)
    v_mfma_f32_16x16x32_bf16 v[52:55], v[116:119], v[20:23], v[52:55]
    ds_read_b64_tr_b16 v[104:105], v232 offset:49152
    ds_read_b64_tr_b16 v[106:107], v232 offset:57344
    s_waitcnt lgkmcnt(8)
    v_mfma_f32_16x16x32_bf16 v[56:59], v[88:91], v[20:23], v[56:59]
    ds_read_b64_tr_b16 v[108:109], v233 offset:49152
    ds_read_b64_tr_b16 v[110:111], v233 offset:57344
    s_waitcnt lgkmcnt(8)
    v_mfma_f32_16x16x32_bf16 v[60:63], v[92:95], v[20:23], v[60:63]
    ds_read_b64_tr_b16 v[112:113], v234 offset:49152
    ds_read_b64_tr_b16 v[114:115], v234 offset:57344
    s_waitcnt lgkmcnt(8)
    v_mfma_f32_16x16x32_bf16 v[64:67], v[96:99], v[20:23], v[64:67]
    ds_read_b64_tr_b16 v[116:117], v235 offset:49152
    ds_read_b64_tr_b16 v[118:119], v235 offset:57344
    s_waitcnt lgkmcnt(8)
    v_mfma_f32_16x16x32_bf16 v[68:71], v[100:103], v[20:23], v[68:71]
    s_waitcnt lgkmcnt(6)
    v_mfma_f32_16x16x32_bf16 v[72:75], v[104:107], v[20:23], v[72:75]
    s_waitcnt lgkmcnt(4)
    v_mfma_f32_16x16x32_bf16 v[76:79], v[108:111], v[20:23], v[76:79]
    s_waitcnt lgkmcnt(2)
    v_mfma_f32_16x16x32_bf16 v[80:83], v[112:115], v[20:23], v[80:83]
    s_waitcnt lgkmcnt(0)
    v_mfma_f32_16x16x32_bf16 v[84:87], v[116:119], v[20:23], v[84:87]
    s_barrier
    ds_read_b128 a[0:3], v216 offset:0
    ds_read_b128 a[4:7], v217 offset:0
    ds_read_b128 a[8:11], v218 offset:0
    ds_read_b128 a[12:15], v219 offset:0
    ds_read_b128 a[16:19], v216 offset:256
    ds_read_b128 a[20:23], v217 offset:256
    ds_read_b128 a[24:27], v218 offset:256
    ds_read_b128 a[28:31], v219 offset:256
    ds_read_b128 a[32:35], v216 offset:8192
    ds_read_b128 a[36:39], v217 offset:8192
    ds_read_b128 a[40:43], v218 offset:8192
    ds_read_b128 a[44:47], v219 offset:8192
    s_waitcnt lgkmcnt(8)
    v_mfma_f32_16x16x32_bf16 v[12:15], a[0:3], a[64:67], 0
    v_mfma_f32_16x16x32_bf16 v[12:15], a[4:7], a[68:71], v[12:15]
    v_mfma_f32_16x16x32_bf16 v[12:15], a[8:11], a[72:75], v[12:15]
    v_mfma_f32_16x16x32_bf16 v[12:15], a[12:15], a[76:79], v[12:15]
    ds_read_b128 a[48:51], v216 offset:8448
    ds_read_b128 a[52:55], v217 offset:8448
    ds_read_b128 a[56:59], v218 offset:8448
    ds_read_b128 a[60:63], v219 offset:8448
    s_waitcnt lgkmcnt(8)
    v_mfma_f32_16x16x32_bf16 v[12:15], a[16:19], a[80:83], v[12:15]
    v_mfma_f32_16x16x32_bf16 v[12:15], a[20:23], a[84:87], v[12:15]
    v_mfma_f32_16x16x32_bf16 v[12:15], a[24:27], a[88:91], v[12:15]
    v_mfma_f32_16x16x32_bf16 v[12:15], a[28:31], a[92:95], v[12:15]
    s_waitcnt lgkmcnt(4)
    v_mfma_f32_16x16x32_bf16 v[16:19], a[32:35], a[64:67], 0
    v_mfma_f32_16x16x32_bf16 v[16:19], a[36:39], a[68:71], v[16:19]
    v_mfma_f32_16x16x32_bf16 v[16:19], a[40:43], a[72:75], v[16:19]
    v_mfma_f32_16x16x32_bf16 v[16:19], a[44:47], a[76:79], v[16:19]
    s_waitcnt lgkmcnt(0)
    v_mfma_f32_16x16x32_bf16 v[16:19], a[48:51], a[80:83], v[16:19]
    v_mfma_f32_16x16x32_bf16 v[16:19], a[52:55], a[84:87], v[16:19]
    v_mfma_f32_16x16x32_bf16 v[16:19], a[56:59], a[88:91], v[16:19]
    v_mfma_f32_16x16x32_bf16 v[16:19], a[60:63], a[92:95], v[16:19]
    s_nop 7
    v_max3_f32 v10, v12, v13, v14
    v_max3_f32 v9, v16, v17, v18
    v_max3_f32 v10, v10, v15, v19
    v_max_f32 v10, v10, v9
    v_mov_b32 v9, v10
    s_nop 1
    v_permlane16_swap_b32 v10, v9
    s_nop 1
    v_max_f32 v10, v10, v9
    v_mov_b32 v9, v10
    s_nop 1
    v_permlane32_swap_b32 v10, v9
    s_nop 1
    v_max_f32 v10, v10, v9
    v_mul_f32 v10, s34, v10
    v_cmp_gt_f32 vcc, v10, v6
    s_cbranch_vccz L_nr_b
    v_max_f32 v9, v6, v10
    v_sub_f32 v8, v6, v9
    v_exp_f32 v8, v8
    v_mov_b32 v6, v9
    v_mul_f32 v7, v7, v8
    v_pk_mul_f32 v[24:25], v[8:9], v[24:25] op_sel:[0,0] op_sel_hi:[0,1]
    v_pk_mul_f32 v[26:27], v[8:9], v[26:27] op_sel:[0,0] op_sel_hi:[0,1]
    v_pk_mul_f32 v[28:29], v[8:9], v[28:29] op_sel:[0,0] op_sel_hi:[0,1]
    v_pk_mul_f32 v[30:31], v[8:9], v[30:31] op_sel:[0,0] op_sel_hi:[0,1]
    v_pk_mul_f32 v[32:33], v[8:9], v[32:33] op_sel:[0,0] op_sel_hi:[0,1]
    v_pk_mul_f32 v[34:35], v[8:9], v[34:35] op_sel:[0,0] op_sel_hi:[0,1]
    v_pk_mul_f32 v[36:37], v[8:9], v[36:37] op_sel:[0,0] op_sel_hi:[0,1]
    v_pk_mul_f32 v[38:39], v[8:9], v[38:39] op_sel:[0,0] op_sel_hi:[0,1]
    v_pk_mul_f32 v[40:41], v[8:9], v[40:41] op_sel:[0,0] op_sel_hi:[0,1]
    v_pk_mul_f32 v[42:43], v[8:9], v[42:43] op_sel:[0,0] op_sel_hi:[0,1]
    v_pk_mul_f32 v[44:45], v[8:9], v[44:45] op_sel:[0,0] op_sel_hi:[0,1]
    v_pk_mul_f32 v[46:47], v[8:9], v[46:47] op_sel:[0,0] op_sel_hi:[0,1]
    v_pk_mul_f32 v[48:49], v[8:9], v[48:49] op_sel:[0,0] op_sel_hi:[0,1]
    v_pk_mul_f32 v[50:51], v[8:9], v[50:51] op_sel:[0,0] op_sel_hi:[0,1]
    v_pk_mul_f32 v[52:53], v[8:9], v[52:53] op_sel:[0,0] op_sel_hi:[0,1]
    v_pk_mul_f32 v[54:55], v[8:9], v[54:55] op_sel:[0,0] op_sel_hi:[0,1]
    v_pk_mul_f32 v[56:57], v[8:9], v[56:57] op_sel:[0,0] op_sel_hi:[0,1]
    v_pk_mul_f32 v[58:59], v[8:9], v[58:59] op_sel:[0,0] op_sel_hi:[0,1]
    v_pk_mul_f32 v[60:61], v[8:9], v[60:61] op_sel:[0,0] op_sel_hi:[0,1]
    v_pk_mul_f32 v[62:63], v[8:9], v[62:63] op_sel:[0,0] op_sel_hi:[0,1]
    v_pk_mul_f32 v[64:65], v[8:9], v[64:65] op_sel:[0,0] op_sel_hi:[0,1]
    v_pk_mul_f32 v[66:67], v[8:9], v[66:67] op_sel:[0,0] op_sel_hi:[0,1]
    v_pk_mul_f32 v[68:69], v[8:9], v[68:69] op_sel:[0,0] op_sel_hi:[0,1]
    v_pk_mul_f32 v[70:71], v[8:9], v[70:71] op_sel:[0,0] op_sel_hi:[0,1]
    v_pk_mul_f32 v[72:73], v[8:9], v[72:73] op_sel:[0,0] op_sel_hi:[0,1]
    v_pk_mul_f32 v[74:75], v[8:9], v[74:75] op_sel:[0,0] op_sel_hi:[0,1]
    v_pk_mul_f32 v[76:77], v[8:9], v[76:77] op_sel:[0,0] op_sel_hi:[0,1]
    v_pk_mul_f32 v[78:79], v[8:9], v[78:79] op_sel:[0,0] op_sel_hi:[0,1]
    v_pk_mul_f32 v[80:81], v[8:9], v[80:81] op_sel:[0,0] op_sel_hi:[0,1]
    v_pk_mul_f32 v[82:83], v[8:9], v[82:83] op_sel:[0,0] op_sel_hi:[0,1]
    v_pk_mul_f32 v[84:85], v[8:9], v[84:85] op_sel:[0,0] op_sel_hi:[0,1]
    v_pk_mul_f32 v[86:87], v[8:9], v[86:87] op_sel:[0,0] op_sel_hi:[0,1]
L_nr_b:
    v_fma_f32 v12, v12, s34, -v6
    v_fma_f32 v13, v13, s34, -v6
    v_fma_f32 v14, v14, s34, -v6
    v_fma_f32 v15, v15, s34, -v6
    v_fma_f32 v16, v16, s34, -v6
    v_fma_f32 v17, v17, s34, -v6
    v_fma_f32 v18, v18, s34, -v6
    v_fma_f32 v19, v19, s34, -v6
    v_exp_f32 v12, v12
    v_exp_f32 v13, v13
    v_exp_f32 v14, v14
    v_exp_f32 v15, v15
    v_exp_f32 v16, v16
    v_exp_f32 v17, v17
    v_exp_f32 v18, v18
    v_exp_f32 v19, v19
    v_add_f32 v10, v12, v13
    v_add_f32 v9, v14, v15
    v_cvt_pk_bf16_f32 v20, v12, v13
    v_cvt_pk_bf16_f32 v21, v14, v15
    v_cvt_pk_bf16_f32 v22, v16, v17
    v_cvt_pk_bf16_f32 v23, v18, v19
    v_add_f32 v10, v10, v16
    v_add_f32 v9, v9, v17
    v_add_f32 v10, v10, v18
    v_add_f32 v9, v9, v19
    v_add_f32 v7, v7, v10
    v_add_f32 v7, v7, v9
    s_barrier
    ds_read_b64_tr_b16 v[88:89], v220 offset:16384
    ds_read_b64_tr_b16 v[90:91], v220 offset:24576
    ds_read_b64_tr_b16 v[92:93], v221 offset:16384
    ds_read_b64_tr_b16 v[94:95], v221 offset:24576
    ds_read_b64_tr_b16 v[96:97], v222 offset:16384
    ds_read_b64_tr_b16 v[98:99], v222 offset:24576
    ds_read_b64_tr_b16 v[100:101], v223 offset:16384
    ds_read_b64_tr_b16 v[102:103], v223 offset:24576
    ds_read_b64_tr_b16 v[104:105], v224 offset:16384
    ds_read_b64_tr_b16 v[106:107], v224 offset:24576
    s_waitcnt lgkmcnt(8)
    v_mfma_f32_16x16x32_bf16 v[24:27], v[88:91], v[20:23], v[24:27]
    ds_read_b64_tr_b16 v[108:109], v225 offset:16384
    ds_read_b64_tr_b16 v[110:111], v225 offset:24576
    s_waitcnt lgkmcnt(8)
    v_mfma_f32_16x16x32_bf16 v[28:31], v[92:95], v[20:23], v[28:31]
    ds_read_b64_tr_b16 v[112:113], v226 offset:16384
    ds_read_b64_tr_b16 v[114:115], v226 offset:24576
    s_waitcnt lgkmcnt(8)
    v_mfma_f32_16x16x32_bf16 v[32:35], v[96:99], v[20:23], v[32:35]
    ds_read_b64_tr_b16 v[116:117], v227 offset:16384
    ds_read_b64_tr_b16 v[118:119], v227 offset:24576
    s_waitcnt lgkmcnt(8)
    v_mfma_f32_16x16x32_bf16 v[36:39], v[100:103], v[20:23], v[36:39]
    ds_read_b64_tr_b16 v[88:89], v228 offset:16384
    ds_read_b64_tr_b16 v[90:91], v228 offset:24576
    s_waitcnt lgkmcnt(8)
    v_mfma_f32_16x16x32_bf16 v[40:43], v[104:107], v[20:23], v[40:43]
    ds_read_b64_tr_b16 v[92:93], v229 offset:16384
    ds_read_b64_tr_b16 v[94:95], v229 offset:24576
    s_waitcnt lgkmcnt(8)
    v_mfma_f32_16x16x32_bf16 v[44:47], v[108:111], v[20:23], v[44:47]
    ds_read_b64_tr_b16 v[96:97], v230 offset:16384
    ds_read_b64_tr_b16 v[98:99], v230 offset:24576
    s_waitcnt lgkmcnt(8)
    v_mfma_f32_16x16x32_bf16 v[48:51], v[112:115], v[20:23], v[48:51]
    ds_read_b64_tr_b16 v[100:101], v231 offset:16384
    ds_read_b64_tr_b16 v[102:103], v231 offset:24576
    s_waitcnt lgkmcnt(8)
    v_mfma_f32_16x16x32_bf16 v[52:55], v[116:119], v[20:23], v[52:55]
    ds_read_b64_tr_b16 v[104:105], v232 offset:16384
    ds_read_b64_tr_b16 v[106:107], v232 offset:24576
    s_waitcnt lgkmcnt(8)
    v_mfma_f32_16x16x32_bf16 v[56:59], v[88:91], v[20:23], v[56:59]
    ds_read_b64_tr_b16 v[108:109], v233 offset:16384
    ds_read_b64_tr_b16 v[110:111], v233 offset:24576
    s_waitcnt lgkmcnt(8)
    v_mfma_f32_16x16x32_bf16 v[60:63], v[92:95], v[20:23], v[60:63]
    ds_read_b64_tr_b16 v[112:113], v234 offset:16384
    ds_read_b64_tr_b16 v[114:115], v234 offset:24576
    s_waitcnt lgkmcnt(8)
    v_mfma_f32_16x16x32_bf16 v[64:67], v[96:99], v[20:23], v[64:67]
    ds_read_b64_tr_b16 v[116:117], v235 offset:16384
    ds_read_b64_tr_b16 v[118:119], v235 offset:24576
    s_waitcnt lgkmcnt(8)
    v_mfma_f32_16x16x32_bf16 v[68:71], v[100:103], v[20:23], v[68:71]
    s_waitcnt lgkmcnt(6)
    v_mfma_f32_16x16x32_bf16 v[72:75], v[104:107], v[20:23], v[72:75]
    s_waitcnt lgkmcnt(4)
    v_mfma_f32_16x16x32_bf16 v[76:79], v[108:111], v[20:23], v[76:79]
    s_waitcnt lgkmcnt(2)
    v_mfma_f32_16x16x32_bf16 v[80:83], v[112:115], v[20:23], v[80:83]
    s_waitcnt lgkmcnt(0)
    v_mfma_f32_16x16x32_bf16 v[84:87], v[116:119], v[20:23], v[84:87]
    s_sub_u32 s53, s53, 1
    s_cmp_lg_u32 s53, 0
    s_cbranch_scc1 L_cloop
L_clast:
    s_barrier
    ds_read_b128 a[0:3], v216 offset:32768
    ds_read_b128 a[4:7], v217 offset:32768
    ds_read_b128 a[8:11], v218 offset:32768
    ds_read_b128 a[12:15], v219 offset:32768
    ds_read_b128 a[16:19], v216 offset:33024
    ds_read_b128 a[20:23], v217 offset:33024
    ds_read_b128 a[24:27], v218 offset:33024
    ds_read_b128 a[28:31], v219 offset:33024
    ds_read_b128 a[32:35], v216 offset:40960
    ds_read_b128 a[36:39], v217 offset:40960
    ds_read_b128 a[40:43], v218 offset:40960
    ds_read_b128 a[44:47], v219 offset:40960
    s_waitcnt lgkmcnt(8)
    v_mfma_f32_16x16x32_bf16 v[12:15], a[0:3], a[64:67], 0
    v_mfma_f32_16x16x32_bf16 v[12:15], a[4:7], a[68:71], v[12:15]
    v_mfma_f32_16x16x32_bf16 v[12:15], a[8:11], a[72:75], v[12:15]
    v_mfma_f32_16x16x32_bf16 v[12:15], a[12:15], a[76:79], v[12:15]
    ds_read_b128 a[48:51], v216 offset:41216
    ds_read_b128 a[52:55], v217 offset:41216
    ds_read_b128 a[56:59], v218 offset:41216
    ds_read_b128 a[60:63], v219 offset:41216
    s_waitcnt lgkmcnt(8)
    v_mfma_f32_16x16x32_bf16 v[12:15], a[16:19], a[80:83], v[12:15]
    v_mfma_f32_16x16x32_bf16 v[12:15], a[20:23], a[84:87], v[12:15]
    v_mfma_f32_16x16x32_bf16 v[12:15], a[24:27], a[88:91], v[12:15]
    v_mfma_f32_16x16x32_bf16 v[12:15], a[28:31], a[92:95], v[12:15]
    s_waitcnt lgkmcnt(4)
    v_mfma_f32_16x16x32_bf16 v[16:19], a[32:35], a[64:67], 0
    v_mfma_f32_16x16x32_bf16 v[16:19], a[36:39], a[68:71], v[16:19]
    v_mfma_f32_16x16x32_bf16 v[16:19], a[40:43], a[72:75], v[16:19]
    v_mfma_f32_16x16x32_bf16 v[16:19], a[44:47], a[76:79], v[16:19]
    s_waitcnt lgkmcnt(0)
    v_mfma_f32_16x16x32_bf16 v[16:19], a[48:51], a[80:83], v[16:19]
    v_mfma_f32_16x16x32_bf16 v[16:19], a[52:55], a[84:87], v[16:19]
    v_mfma_f32_16x16x32_bf16 v[16:19], a[56:59], a[88:91], v[16:19]
    v_mfma_f32_16x16x32_bf16 v[16:19], a[60:63], a[92:95], v[16:19]
    s_nop 7
    v_max3_f32 v10, v12, v13, v14
    v_max3_f32 v9, v16, v17, v18
    v_max3_f32 v10, v10, v15, v19
    v_max_f32 v10, v10, v9
    v_mov_b32 v9, v10
    s_nop 1
    v_permlane16_swap_b32 v10, v9
    s_nop 1
    v_max_f32 v10, v10, v9
    v_mov_b32 v9, v10
    s_nop 1
    v_permlane32_swap_b32 v10, v9
    s_nop 1
    v_max_f32 v10, v10, v9
    v_mul_f32 v10, s34, v10
    v_max_f32 v10, v6, v10
    ds_write_b32 v241, v10
    s_waitcnt lgkmcnt(0)
    s_barrier
    ds_read_b32 v9, v242
    s_waitcnt lgkmcnt(0)
    v_max_f32 v10, v10, v9
    v_max_f32 v9, v6, v10
    v_sub_f32 v8, v6, v9
    v_exp_f32 v8, v8
    v_mov_b32 v6, v9
    v_mul_f32 v7, v7, v8
    v_pk_mul_f32 v[24:25], v[8:9], v[24:25] op_sel:[0,0] op_sel_hi:[0,1]
    v_pk_mul_f32 v[26:27], v[8:9], v[26:27] op_sel:[0,0] op_sel_hi:[0,1]
    v_pk_mul_f32 v[28:29], v[8:9], v[28:29] op_sel:[0,0] op_sel_hi:[0,1]
    v_pk_mul_f32 v[30:31], v[8:9], v[30:31] op_sel:[0,0] op_sel_hi:[0,1]
    v_pk_mul_f32 v[32:33], v[8:9], v[32:33] op_sel:[0,0] op_sel_hi:[0,1]
    v_pk_mul_f32 v[34:35], v[8:9], v[34:35] op_sel:[0,0] op_sel_hi:[0,1]
    v_pk_mul_f32 v[36:37], v[8:9], v[36:37] op_sel:[0,0] op_sel_hi:[0,1]
    v_pk_mul_f32 v[38:39], v[8:9], v[38:39] op_sel:[0,0] op_sel_hi:[0,1]
    v_pk_mul_f32 v[40:41], v[8:9], v[40:41] op_sel:[0,0] op_sel_hi:[0,1]
    v_pk_mul_f32 v[42:43], v[8:9], v[42:43] op_sel:[0,0] op_sel_hi:[0,1]
    v_pk_mul_f32 v[44:45], v[8:9], v[44:45] op_sel:[0,0] op_sel_hi:[0,1]
    v_pk_mul_f32 v[46:47], v[8:9], v[46:47] op_sel:[0,0] op_sel_hi:[0,1]
    v_pk_mul_f32 v[48:49], v[8:9], v[48:49] op_sel:[0,0] op_sel_hi:[0,1]
    v_pk_mul_f32 v[50:51], v[8:9], v[50:51] op_sel:[0,0] op_sel_hi:[0,1]
    v_pk_mul_f32 v[52:53], v[8:9], v[52:53] op_sel:[0,0] op_sel_hi:[0,1]
    v_pk_mul_f32 v[54:55], v[8:9], v[54:55] op_sel:[0,0] op_sel_hi:[0,1]
    v_pk_mul_f32 v[56:57], v[8:9], v[56:57] op_sel:[0,0] op_sel_hi:[0,1]
    v_pk_mul_f32 v[58:59], v[8:9], v[58:59] op_sel:[0,0] op_sel_hi:[0,1]
    v_pk_mul_f32 v[60:61], v[8:9], v[60:61] op_sel:[0,0] op_sel_hi:[0,1]
    v_pk_mul_f32 v[62:63], v[8:9], v[62:63] op_sel:[0,0] op_sel_hi:[0,1]
    v_pk_mul_f32 v[64:65], v[8:9], v[64:65] op_sel:[0,0] op_sel_hi:[0,1]
    v_pk_mul_f32 v[66:67], v[8:9], v[66:67] op_sel:[0,0] op_sel_hi:[0,1]
    v_pk_mul_f32 v[68:69], v[8:9], v[68:69] op_sel:[0,0] op_sel_hi:[0,1]
    v_pk_mul_f32 v[70:71], v[8:9], v[70:71] op_sel:[0,0] op_sel_hi:[0,1]
    v_pk_mul_f32 v[72:73], v[8:9], v[72:73] op_sel:[0,0] op_sel_hi:[0,1]
    v_pk_mul_f32 v[74:75], v[8:9], v[74:75] op_sel:[0,0] op_sel_hi:[0,1]
    v_pk_mul_f32 v[76:77], v[8:9], v[76:77] op_sel:[0,0] op_sel_hi:[0,1]
    v_pk_mul_f32 v[78:79], v[8:9], v[78:79] op_sel:[0,0] op_sel_hi:[0,1]
    v_pk_mul_f32 v[80:81], v[8:9], v[80:81] op_sel:[0,0] op_sel_hi:[0,1]
    v_pk_mul_f32 v[82:83], v[8:9], v[82:83] op_sel:[0,0] op_sel_hi:[0,1]
    v_pk_mul_f32 v[84:85], v[8:9], v[84:85] op_sel:[0,0] op_sel_hi:[0,1]
    v_pk_mul_f32 v[86:87], v[8:9], v[86:87] op_sel:[0,0] op_sel_hi:[0,1]
    v_fma_f32 v12, v12, s34, -v6
    v_fma_f32 v13, v13, s34, -v6
    v_fma_f32 v14, v14, s34, -v6
    v_fma_f32 v15, v15, s34, -v6
    v_fma_f32 v16, v16, s34, -v6
    v_fma_f32 v17, v17, s34, -v6
    v_fma_f32 v18, v18, s34, -v6
    v_fma_f32 v19, v19, s34, -v6
    v_exp_f32 v12, v12
    v_exp_f32 v13, v13
    v_exp_f32 v14, v14
    v_exp_f32 v15, v15
    v_exp_f32 v16, v16
    v_exp_f32 v17, v17
    v_exp_f32 v18, v18
    v_exp_f32 v19, v19
    v_add_f32 v10, v12, v13
    v_add_f32 v9, v14, v15
    v_cvt_pk_bf16_f32 v20, v12, v13
    v_cvt_pk_bf16_f32 v21, v14, v15
    v_cvt_pk_bf16_f32 v22, v16, v17
    v_cvt_pk_bf16_f32 v23, v18, v19
    v_add_f32 v10, v10, v16
    v_add_f32 v9, v9, v17
    v_add_f32 v10, v10, v18
    v_add_f32 v9, v9, v19
    v_add_f32 v7, v7, v10
    v_add_f32 v7, v7, v9
    v_mov_b32 v9, v7
    s_nop 1
    v_permlane16_swap_b32 v7, v9
    s_nop 1
    v_add_f32 v7, v7, v9
    v_mov_b32 v9, v7
    s_nop 1
    v_permlane32_swap_b32 v7, v9
    s_nop 1
    v_add_f32 v11, v7, v9
    v_mov_b32 v10, v6
    ds_write_b32 v241, v11 offset:4
    s_waitcnt lgkmcnt(0)
    s_barrier
    ds_read_b32 v9, v254
    ds_read_b32 v13, v242 offset:4
    ds_read_b64_tr_b16 v[88:89], v228 offset:49152
    ds_read_b64_tr_b16 v[90:91], v228 offset:57344
    ds_read_b64_tr_b16 v[92:93], v229 offset:49152
    ds_read_b64_tr_b16 v[94:95], v229 offset:57344
    ds_read_b64_tr_b16 v[96:97], v230 offset:49152
    ds_read_b64_tr_b16 v[98:99], v230 offset:57344
    ds_read_b64_tr_b16 v[100:101], v231 offset:49152
    ds_read_b64_tr_b16 v[102:103], v231 offset:57344
    s_waitcnt lgkmcnt(8)
    v_readfirstlane_b32 s54, v9
    v_add_f32 v11, v11, v13
    v_lshl_add_u32 v3, v0, 1, s30
    v_add_u32 v3, 16, v3
    v_lshrrev_b32 v3, v3, v9
    s_and_b32 s35, s54, 0xff
    s_and_b32 s54, s54, 0xffff
    s_cmp_eq_u32 s54, 0x103
    s_cbranch_scc1 L_early
    s_cmp_lg_u32 s35, 3
    s_cbranch_scc1 L_plain
    s_mov_b64 exec, 15
    global_load_dword v2, v255, s[48:49] sc1
    s_mov_b64 exec, -1
L_plain:
    s_waitcnt lgkmcnt(6)
    v_mfma_f32_16x16x32_bf16 v[56:59], v[88:91], v[20:23], v[56:59]
    ds_read_b64_tr_b16 v[104:105], v232 offset:49152
    ds_read_b64_tr_b16 v[106:107], v232 offset:57344
    s_waitcnt lgkmcnt(6)
    v_mfma_f32_16x16x32_bf16 v[60:63], v[92:95], v[20:23], v[60:63]
    ds_read_b64_tr_b16 v[108:109], v233 offset:49152
    ds_read_b64_tr_b16 v[110:111], v233 offset:57344
    s_waitcnt lgkmcnt(6)
    v_mfma_f32_16x16x32_bf16 v[64:67], v[96:99], v[20:23], v[64:67]
    ds_read_b64_tr_b16 v[112:113], v234 offset:49152
    ds_read_b64_tr_b16 v[114:115], v234 offset:57344
    s_waitcnt lgkmcnt(6)
    v_mfma_f32_16x16x32_bf16 v[68:71], v[100:103], v[20:23], v[68:71]
    ds_read_b64_tr_b16 v[116:117], v235 offset:49152
    ds_read_b64_tr_b16 v[118:119], v235 offset:57344
    ds_write_b128 v236, v[56:59] offset:8192
    s_waitcnt lgkmcnt(7)
    v_mfma_f32_16x16x32_bf16 v[72:75], v[104:107], v[20:23], v[72:75]
    ds_read_b64_tr_b16 v[88:89], v220 offset:49152
    ds_read_b64_tr_b16 v[90:91], v220 offset:57344
    ds_write_b128 v236, v[60:63] offset:9216
    s_waitcnt lgkmcnt(8)
    v_mfma_f32_16x16x32_bf16 v[76:79], v[108:111], v[20:23], v[76:79]
    ds_read_b64_tr_b16 v[92:93], v221 offset:49152
    ds_read_b64_tr_b16 v[94:95], v221 offset:57344
    ds_write_b128 v236, v[64:67] offset:10240
    s_waitcnt lgkmcnt(9)
    v_mfma_f32_16x16x32_bf16 v[80:83], v[112:115], v[20:23], v[80:83]
    ds_read_b64_tr_b16 v[96:97], v222 offset:49152
    ds_read_b64_tr_b16 v[98:99], v222 offset:57344
    ds_write_b128 v236, v[68:71] offset:11264
    s_waitcnt lgkmcnt(10)
    v_mfma_f32_16x16x32_bf16 v[84:87], v[116:119], v[20:23], v[84:87]
    ds_read_b64_tr_b16 v[100:101], v223 offset:49152
    ds_read_b64_tr_b16 v[102:103], v223 offset:57344
    ds_write_b128 v236, v[72:75] offset:12288
    s_waitcnt lgkmcnt(10)
    v_mfma_f32_16x16x32_bf16 v[24:27], v[88:91], v[20:23], v[24:27]
    ds_read_b64_tr_b16 v[104:105], v224 offset:49152
    ds_read_b64_tr_b16 v[106:107], v224 offset:57344
    ds_write_b128 v236, v[76:79] offset:13312
    s_waitcnt lgkmcnt(10)
    v_mfma_f32_16x16x32_bf16 v[28:31], v[92:95], v[20:23], v[28:31]
    ds_read_b64_tr_b16 v[108:109], v225 offset:49152
    ds_read_b64_tr_b16 v[110:111], v225 offset:57344
    ds_write_b128 v236, v[80:83] offset:14336
    s_waitcnt lgkmcnt(10)
    v_mfma_f32_16x16x32_bf16 v[32:35], v[96:99], v[20:23], v[32:35]
    ds_read_b64_tr_b16 v[112:113], v226 offset:49152
    ds_read_b64_tr_b16 v[114:115], v226 offset:57344
    ds_write_b128 v236, v[84:87] offset:15360
    s_waitcnt lgkmcnt(10)
    v_mfma_f32_16x16x32_bf16 v[36:39], v[100:103], v[20:23], v[36:39]
    ds_read_b64_tr_b16 v[116:117], v227 offset:49152
    ds_read_b64_tr_b16 v[118:119], v227 offset:57344
    s_waitcnt lgkmcnt(9)
    v_mfma_f32_16x16x32_bf16 v[40:43], v[104:107], v[20:23], v[40:43]
    s_waitcnt lgkmcnt(6)
    v_mfma_f32_16x16x32_bf16 v[44:47], v[108:111], v[20:23], v[44:47]
    s_waitcnt lgkmcnt(3)
    v_mfma_f32_16x16x32_bf16 v[48:51], v[112:115], v[20:23], v[48:51]
    s_waitcnt lgkmcnt(0)
    v_mfma_f32_16x16x32_bf16 v[52:55], v[116:119], v[20:23], v[52:55]
    s_branch L_pvdone
L_early:
    s_waitcnt lgkmcnt(6)
    v_mfma_f32_16x16x32_bf16 v[56:59], v[88:91], v[20:23], v[56:59]
    ds_read_b64_tr_b16 v[104:105], v232 offset:49152
    ds_read_b64_tr_b16 v[106:107], v232 offset:57344
    buffer_load_dwordx2 v[244:245], v240, s[36:39], s91 offen sc1
    buffer_load_dwordx2 v[246:247], v240, s[36:39], s92 offen sc1
    s_waitcnt lgkmcnt(6)
    v_mfma_f32_16x16x32_bf16 v[60:63], v[92:95], v[20:23], v[60:63]
    ds_read_b64_tr_b16 v[108:109], v233 offset:49152
    ds_read_b64_tr_b16 v[110:111], v233 offset:57344
    buffer_load_dwordx2 v[248:249], v240, s[36:39], s93 offen sc1
    buffer_load_dwordx4 v[120:123], v238, s[36:39], s88 offen offset:0 sc1
    s_waitcnt lgkmcnt(6)
    v_mfma_f32_16x16x32_bf16 v[64:67], v[96:99], v[20:23], v[64:67]
    ds_read_b64_tr_b16 v[112:113], v234 offset:49152
    ds_read_b64_tr_b16 v[114:115], v234 offset:57344
    buffer_load_dwordx4 v[124:127], v238, s[36:39], s88 offen offset:1024 sc1
    buffer_load_dwordx4 v[128:131], v238, s[36:39], s88 offen offset:2048 sc1
    s_waitcnt lgkmcnt(6)
    v_mfma_f32_16x16x32_bf16 v[68:71], v[100:103], v[20:23], v[68:71]
    ds_read_b64_tr_b16 v[116:117], v235 offset:49152
    ds_read_b64_tr_b16 v[118:119], v235 offset:57344
    buffer_load_dwordx4 v[132:135], v238, s[36:39], s88 offen offset:3072 sc1
    buffer_load_dwordx4 v[136:139], v239, s[36:39], s88 offen offset:0 sc1
    ds_write_b128 v236, v[56:59] offset:8192
    s_waitcnt lgkmcnt(7)
    v_mfma_f32_16x16x32_bf16 v[72:75], v[104:107], v[20:23], v[72:75]
    ds_read_b64_tr_b16 v[88:89], v220 offset:49152
    ds_read_b64_tr_b16 v[90:91], v220 offset:57344
    buffer_load_dwordx4 v[140:143], v239, s[36:39], s88 offen offset:1024 sc1
    buffer_load_dwordx4 v[144:147], v239, s[36:39], s88 offen offset:2048 sc1
    ds_write_b128 v236, v[60:63] offset:9216
    s_waitcnt lgkmcnt(8)
    v_mfma_f32_16x16x32_bf16 v[76:79], v[108:111], v[20:23], v[76:79]
    ds_read_b64_tr_b16 v[92:93], v221 offset:49152
    ds_read_b64_tr_b16 v[94:95], v221 offset:57344
    buffer_load_dwordx4 v[148:151], v239, s[36:39], s88 offen offset:3072 sc1
    buffer_load_dwordx4 v[152:155], v238, s[36:39], s89 offen offset:0 sc1
    ds_write_b128 v236, v[64:67] offset:10240
    s_waitcnt lgkmcnt(9)
    v_mfma_f32_16x16x32_bf16 v[80:83], v[112:115], v[20:23], v[80:83]
    ds_read_b64_tr_b16 v[96:97], v222 offset:49152
    ds_read_b64_tr_b16 v[98:99], v222 offset:57344
    buffer_load_dwordx4 v[156:159], v238, s[36:39], s89 offen offset:1024 sc1
    buffer_load_dwordx4 v[160:163], v238, s[36:39], s89 offen offset:2048 sc1
    ds_write_b128 v236, v[68:71] offset:11264
    s_waitcnt lgkmcnt(10)
    v_mfma_f32_16x16x32_bf16 v[84:87], v[116:119], v[20:23], v[84:87]
    ds_read_b64_tr_b16 v[100:101], v223 offset:49152
    ds_read_b64_tr_b16 v[102:103], v223 offset:57344
    buffer_load_dwordx4 v[164:167], v238, s[36:39], s89 offen offset:3072 sc1
    buffer_load_dwordx4 v[168:171], v239, s[36:39], s89 offen offset:0 sc1
    ds_write_b128 v236, v[72:75] offset:12288
    s_waitcnt lgkmcnt(10)
    v_mfma_f32_16x16x32_bf16 v[24:27], v[88:91], v[20:23], v[24:27]
    ds_read_b64_tr_b16 v[104:105], v224 offset:49152
    ds_read_b64_tr_b16 v[106:107], v224 offset:57344
    buffer_load_dwordx4 v[172:175], v239, s[36:39], s89 offen offset:1024 sc1
    buffer_load_dwordx4 v[176:179], v239, s[36:39], s89 offen offset:2048 sc1
    ds_write_b128 v236, v[76:79] offset:13312
    s_waitcnt lgkmcnt(10)
    v_mfma_f32_16x16x32_bf16 v[28:31], v[92:95], v[20:23], v[28:31]
    ds_read_b64_tr_b16 v[108:109], v225 offset:49152
    ds_read_b64_tr_b16 v[110:111], v225 offset:57344
    buffer_load_dwordx4 v[180:183], v239, s[36:39], s89 offen offset:3072 sc1
    buffer_load_dwordx4 v[184:187], v238, s[36:39], s90 offen offset:0 sc1
    ds_write_b128 v236, v[80:83] offset:14336
    s_waitcnt lgkmcnt(10)
    v_mfma_f32_16x16x32_bf16 v[32:35], v[96:99], v[20:23], v[32:35]
    ds_read_b64_tr_b16 v[112:113], v226 offset:49152
    ds_read_b64_tr_b16 v[114:115], v226 offset:57344
    buffer_load_dwordx4 v[188:191], v238, s[36:39], s90 offen offset:1024 sc1
    buffer_load_dwordx4 v[192:195], v238, s[36:39], s90 offen offset:2048 sc1
    ds_write_b128 v236, v[84:87] offset:15360
    s_waitcnt lgkmcnt(10)
    v_mfma_f32_16x16x32_bf16 v[36:39], v[100:103], v[20:23], v[36:39]
    ds_read_b64_tr_b16 v[116:117], v227 offset:49152
    ds_read_b64_tr_b16 v[118:119], v227 offset:57344
    buffer_load_dwordx4 v[196:199], v238, s[36:39], s90 offen offset:3072 sc1
    buffer_load_dwordx4 v[200:203], v239, s[36:39], s90 offen offset:0 sc1
    s_waitcnt lgkmcnt(9)
    v_mfma_f32_16x16x32_bf16 v[40:43], v[104:107], v[20:23], v[40:43]
    buffer_load_dwordx4 v[204:207], v239, s[36:39], s90 offen offset:1024 sc1
    buffer_load_dwordx4 v[208:211], v239, s[36:39], s90 offen offset:2048 sc1
    s_waitcnt lgkmcnt(6)
    v_mfma_f32_16x16x32_bf16 v[44:47], v[108:111], v[20:23], v[44:47]
    buffer_load_dwordx4 v[212:215], v239, s[36:39], s90 offen offset:3072 sc1
    s_waitcnt lgkmcnt(3)
    v_mfma_f32_16x16x32_bf16 v[48:51], v[112:115], v[20:23], v[48:51]
    s_waitcnt lgkmcnt(0)
    v_mfma_f32_16x16x32_bf16 v[52:55], v[116:119], v[20:23], v[52:55]
L_pvdone:
    s_waitcnt lgkmcnt(0)
    s_barrier
    ds_read_b128 v[56:59], v237 offset:8192
    ds_read_b128 v[60:63], v237 offset:9216
    ds_read_b128 v[64:67], v237 offset:10240
    ds_read_b128 v[68:71], v237 offset:11264
    ds_read_b128 v[72:75], v237 offset:12288
    ds_read_b128 v[76:79], v237 offset:13312
    ds_read_b128 v[80:83], v237 offset:14336
    ds_read_b128 v[84:87], v237 offset:15360
    s_cmp_lg_u32 s35, 3
    s_cbranch_scc1 L_comb
    s_cmp_eq_u32 s54, 0x103
    s_cbranch_scc1 L_comb
    s_waitcnt vmcnt(0)
    v_xor_b32 v2, v2, v3
    v_and_b32 v2, 1, v2
    v_cmp_eq_u32 vcc, 1, v2
    s_or_b64 vcc, vcc, s[32:33]
    s_and_b32 vcc_lo, vcc_lo, 15
    s_cmp_eq_u32 vcc_lo, 15
    s_cbranch_scc1 L_got1
    s_mov_b64 exec, 15
    global_load_dword v2, v255, s[48:49] sc1
    s_mov_b64 exec, -1
    s_branch L_comb
L_got1:
    s_mov_b32 s54, 0x103
    buffer_load_dwordx2 v[244:245], v240, s[36:39], s91 offen sc1
    buffer_load_dwordx2 v[246:247], v240, s[36:39], s92 offen sc1
    buffer_load_dwordx2 v[248:249], v240, s[36:39], s93 offen sc1
    buffer_load_dwordx4 v[120:123], v238, s[36:39], s88 offen offset:0 sc1
    buffer_load_dwordx4 v[124:127], v238, s[36:39], s88 offen offset:1024 sc1
    buffer_load_dwordx4 v[128:131], v238, s[36:39], s88 offen offset:2048 sc1
    buffer_load_dwordx4 v[132:135], v238, s[36:39], s88 offen offset:3072 sc1
    buffer_load_dwordx4 v[136:139], v239, s[36:39], s88 offen offset:0 sc1
    buffer_load_dwordx4 v[140:143], v239, s[36:39], s88 offen offset:1024 sc1
    buffer_load_dwordx4 v[144:147], v239, s[36:39], s88 offen offset:2048 sc1
    buffer_load_dwordx4 v[148:151], v239, s[36:39], s88 offen offset:3072 sc1
    buffer_load_dwordx4 v[152:155], v238, s[36:39], s89 offen offset:0 sc1
    buffer_load_dwordx4 v[156:159], v238, s[36:39], s89 offen offset:1024 sc1
    buffer_load_dwordx4 v[160:163], v238, s[36:39], s89 offen offset:2048 sc1
    buffer_load_dwordx4 v[164:167], v238, s[36:39], s89 offen offset:3072 sc1
    buffer_load_dwordx4 v[168:171], v239, s[36:39], s89 offen offset:0 sc1
    buffer_load_dwordx4 v[172:175], v239, s[36:39], s89 offen offset:1024 sc1
    buffer_load_dwordx4 v[176:179], v239, s[36:39], s89 offen offset:2048 sc1
    buffer_load_dwordx4 v[180:183], v239, s[36:39], s89 offen offset:3072 sc1
    buffer_load_dwordx4 v[184:187], v238, s[36:39], s90 offen offset:0 sc1
    buffer_load_dwordx4 v[188:191], v238, s[36:39], s90 offen offset:1024 sc1
    buffer_load_dwordx4 v[192:195], v238, s[36:39], s90 offen offset:2048 sc1
    buffer_load_dwordx4 v[196:199], v238, s[36:39], s90 offen offset:3072 sc1
    buffer_load_dwordx4 v[200:203], v239, s[36:39], s90 offen offset:0 sc1
    buffer_load_dwordx4 v[204:207], v239, s[36:39], s90 offen offset:1024 sc1
    buffer_load_dwordx4 v[208:211], v239, s[36:39], s90 offen offset:2048 sc1
    buffer_load_dwordx4 v[212:215], v239, s[36:39], s90 offen offset:3072 sc1
L_comb:
    s_waitcnt lgkmcnt(6)
    v_pk_add_f32 v[24:25], v[24:25], v[56:57]
    v_pk_add_f32 v[26:27], v[26:27], v[58:59]
    v_pk_add_f32 v[28:29], v[28:29], v[60:61]
    v_pk_add_f32 v[30:31], v[30:31], v[62:63]
    s_waitcnt lgkmcnt(4)
    v_pk_add_f32 v[32:33], v[32:33], v[64:65]
    v_pk_add_f32 v[34:35], v[34:35], v[66:67]
    v_pk_add_f32 v[36:37], v[36:37], v[68:69]
    v_pk_add_f32 v[38:39], v[38:39], v[70:71]
    s_waitcnt lgkmcnt(2)
    v_pk_add_f32 v[40:41], v[40:41], v[72:73]
    v_pk_add_f32 v[42:43], v[42:43], v[74:75]
    v_pk_add_f32 v[44:45], v[44:45], v[76:77]
    v_pk_add_f32 v[46:47], v[46:47], v[78:79]
    s_waitcnt lgkmcnt(0)
    v_pk_add_f32 v[48:49], v[48:49], v[80:81]
    v_pk_add_f32 v[50:51], v[50:51], v[82:83]
    v_pk_add_f32 v[52:53], v[52:53], v[84:85]
    v_pk_add_f32 v[54:55], v[54:55], v[86:87]
    s_cmp_lg_u32 s35, 3
    s_cbranch_scc1 L_publish
    s_cmp_eq_u32 s54, 0x103
    s_cbranch_scc1 L_final
L_poll:
    s_waitcnt vmcnt(0)
    v_xor_b32 v2, v2, v3
    v_and_b32 v2, 1, v2
    v_cmp_eq_u32 vcc, 1, v2
    s_or_b64 vcc, vcc, s[32:33]
    s_and_b32 vcc_lo, vcc_lo, 15
    s_cmp_eq_u32 vcc_lo, 15
    s_cbranch_scc1 L_seen
    s_mov_b64 exec, 15
    global_load_dword v2, v255, s[48:49] sc1
    s_mov_b64 exec, -1
    s_branch L_poll
L_seen:
    buffer_load_dwordx2 v[244:245], v240, s[36:39], s91 offen sc1
    buffer_load_dwordx2 v[246:247], v240, s[36:39], s92 offen sc1
    buffer_load_dwordx2 v[248:249], v240, s[36:39], s93 offen sc1
    buffer_load_dwordx4 v[120:123], v238, s[36:39], s88 offen offset:0 sc1
    buffer_load_dwordx4 v[124:127], v238, s[36:39], s88 offen offset:1024 sc1
    buffer_load_dwordx4 v[128:131], v238, s[36:39], s88 offen offset:2048 sc1
    buffer_load_dwordx4 v[132:135], v238, s[36:39], s88 offen offset:3072 sc1
    buffer_load_dwordx4 v[136:139], v239, s[36:39], s88 offen offset:0 sc1
    buffer_load_dwordx4 v[140:143], v239, s[36:39], s88 offen offset:1024 sc1
    buffer_load_dwordx4 v[144:147], v239, s[36:39], s88 offen offset:2048 sc1
    buffer_load_dwordx4 v[148:151], v239, s[36:39], s88 offen offset:3072 sc1
    buffer_load_dwordx4 v[152:155], v238, s[36:39], s89 offen offset:0 sc1
    buffer_load_dwordx4 v[156:159], v238, s[36:39], s89 offen offset:1024 sc1
    buffer_load_dwordx4 v[160:163], v238, s[36:39], s89 offen offset:2048 sc1
    buffer_load_dwordx4 v[164:167], v238, s[36:39], s89 offen offset:3072 sc1
    buffer_load_dwordx4 v[168:171], v239, s[36:39], s89 offen offset:0 sc1
    buffer_load_dwordx4 v[172:175], v239, s[36:39], s89 offen offset:1024 sc1
    buffer_load_dwordx4 v[176:179], v239, s[36:39], s89 offen offset:2048 sc1
    buffer_load_dwordx4 v[180:183], v239, s[36:39], s89 offen offset:3072 sc1
    buffer_load_dwordx4 v[184:187], v238, s[36:39], s90 offen offset:0 sc1
    buffer_load_dwordx4 v[188:191], v238, s[36:39], s90 offen offset:1024 sc1
    buffer_load_dwordx4 v[192:195], v238, s[36:39], s90 offen offset:2048 sc1
    buffer_load_dwordx4 v[196:199], v238, s[36:39], s90 offen offset:3072 sc1
    buffer_load_dwordx4 v[200:203], v239, s[36:39], s90 offen offset:0 sc1
    buffer_load_dwordx4 v[204:207], v239, s[36:39], s90 offen offset:1024 sc1
    buffer_load_dwordx4 v[208:211], v239, s[36:39], s90 offen offset:2048 sc1
    buffer_load_dwordx4 v[212:215], v239, s[36:39], s90 offen offset:3072 sc1
L_final:
    s_waitcnt vmcnt(24)
    v_max3_f32 v8, v10, v244, v246
    v_max_f32 v8, v8, v248
    v_sub_f32 v250, v10, v8
    v_sub_f32 v251, v244, v8
    v_sub_f32 v252, v246, v8
    v_sub_f32 v253, v248, v8
    v_exp_f32 v250, v250
    v_exp_f32 v251, v251
    v_exp_f32 v252, v252
    v_exp_f32 v253, v253
    s_nop 0
    v_mul_f32 v9, v250, v11
    v_mul_f32 v12, v251, v245
    v_mul_f32 v13, v252, v247
    v_mul_f32 v14, v253, v249
    v_add_f32 v9, v9, v12
    v_add_f32 v13, v13, v14
    v_add_f32 v9, v9, v13
    v_rcp_f32 v9, v9
    s_nop 0
    v_mul_f32 v250, v250, v9
    v_mul_f32 v251, v251, v9
    v_mul_f32 v252, v252, v9
    v_mul_f32 v253, v253, v9
    s_bitcmp1_b32 s29, 0
    s_cbranch_scc1 L_odd
    v_pk_mul_f32 v[24:25], v[250:251], v[24:25] op_sel:[0,0] op_sel_hi:[0,1]
    v_pk_mul_f32 v[26:27], v[250:251], v[26:27] op_sel:[0,0] op_sel_hi:[0,1]
    v_pk_mul_f32 v[28:29], v[250:251], v[28:29] op_sel:[0,0] op_sel_hi:[0,1]
    v_pk_mul_f32 v[30:31], v[250:251], v[30:31] op_sel:[0,0] op_sel_hi:[0,1]
    v_pk_mul_f32 v[32:33], v[250:251], v[32:33] op_sel:[0,0] op_sel_hi:[0,1]
    v_pk_mul_f32 v[34:35], v[250:251], v[34:35] op_sel:[0,0] op_sel_hi:[0,1]
    v_pk_mul_f32 v[36:37], v[250:251], v[36:37] op_sel:[0,0] op_sel_hi:[0,1]
    v_pk_mul_f32 v[38:39], v[250:251], v[38:39] op_sel:[0,0] op_sel_hi:[0,1]
    v_pk_mul_f32 v[40:41], v[250:251], v[40:41] op_sel:[0,0] op_sel_hi:[0,1]
    v_pk_mul_f32 v[42:43], v[250:251], v[42:43] op_sel:[0,0] op_sel_hi:[0,1]
    v_pk_mul_f32 v[44:45], v[250:251], v[44:45] op_sel:[0,0] op_sel_hi:[0,1]
    v_pk_mul_f32 v[46:47], v[250:251], v[46:47] op_sel:[0,0] op_sel_hi:[0,1]
    v_pk_mul_f32 v[48:49], v[250:251], v[48:49] op_sel:[0,0] op_sel_hi:[0,1]
    v_pk_mul_f32 v[50:51], v[250:251], v[50:51] op_sel:[0,0] op_sel_hi:[0,1]
    v_pk_mul_f32 v[52:53], v[250:251], v[52:53] op_sel:[0,0] op_sel_hi:[0,1]
    v_pk_mul_f32 v[54:55], v[250:251], v[54:55] op_sel:[0,0] op_sel_hi:[0,1]
    s_waitcnt vmcnt(20)
    v_pk_fma_f32 v[24:25], v[250:251], v[120:121], v[24:25] op_sel:[1,0,0] op_sel_hi:[1,1,1]
    v_pk_fma_f32 v[26:27], v[250:251], v[122:123], v[26:27] op_sel:[1,0,0] op_sel_hi:[1,1,1]
    v_pk_fma_f32 v[28:29], v[250:251], v[124:125], v[28:29] op_sel:[1,0,0] op_sel_hi:[1,1,1]
    v_pk_fma_f32 v[30:31], v[250:251], v[126:127], v[30:31] op_sel:[1,0,0] op_sel_hi:[1,1,1]
    v_pk_fma_f32 v[32:33], v[250:251], v[128:129], v[32:33] op_sel:[1,0,0] op_sel_hi:[1,1,1]
    v_pk_fma_f32 v[34:35], v[250:251], v[130:131], v[34:35] op_sel:[1,0,0] op_sel_hi:[1,1,1]
    v_pk_fma_f32 v[36:37], v[250:251], v[132:133], v[36:37] op_sel:[1,0,0] op_sel_hi:[1,1,1]
    v_pk_fma_f32 v[38:39], v[250:251], v[134:135], v[38:39] op_sel:[1,0,0] op_sel_hi:[1,1,1]
    s_waitcnt vmcnt(16)
    v_pk_fma_f32 v[40:41], v[250:251], v[136:137], v[40:41] op_sel:[1,0,0] op_sel_hi:[1,1,1]
    v_pk_fma_f32 v[42:43], v[250:251], v[138:139], v[42:43] op_sel:[1,0,0] op_sel_hi:[1,1,1]
    v_pk_fma_f32 v[44:45], v[250:251], v[140:141], v[44:45] op_sel:[1,0,0] op_sel_hi:[1,1,1]
    v_pk_fma_f32 v[46:47], v[250:251], v[142:143], v[46:47] op_sel:[1,0,0] op_sel_hi:[1,1,1]
    v_pk_fma_f32 v[48:49], v[250:251], v[144:145], v[48:49] op_sel:[1,0,0] op_sel_hi:[1,1,1]
    v_pk_fma_f32 v[50:51], v[250:251], v[146:147], v[50:51] op_sel:[1,0,0] op_sel_hi:[1,1,1]
    v_pk_fma_f32 v[52:53], v[250:251], v[148:149], v[52:53] op_sel:[1,0,0] op_sel_hi:[1,1,1]
    v_pk_fma_f32 v[54:55], v[250:251], v[150:151], v[54:55] op_sel:[1,0,0] op_sel_hi:[1,1,1]
    s_branch L_pair2
L_odd:
    s_waitcnt vmcnt(20)
    v_pk_mul_f32 v[120:121], v[250:251], v[120:121] op_sel:[1,0] op_sel_hi:[1,1]
    v_pk_mul_f32 v[122:123], v[250:251], v[122:123] op_sel:[1,0] op_sel_hi:[1,1]
    v_pk_mul_f32 v[124:125], v[250:251], v[124:125] op_sel:[1,0] op_sel_hi:[1,1]
    v_pk_mul_f32 v[126:127], v[250:251], v[126:127] op_sel:[1,0] op_sel_hi:[1,1]
    v_pk_mul_f32 v[128:129], v[250:251], v[128:129] op_sel:[1,0] op_sel_hi:[1,1]
    v_pk_mul_f32 v[130:131], v[250:251], v[130:131] op_sel:[1,0] op_sel_hi:[1,1]
    v_pk_mul_f32 v[132:133], v[250:251], v[132:133] op_sel:[1,0] op_sel_hi:[1,1]
    v_pk_mul_f32 v[134:135], v[250:251], v[134:135] op_sel:[1,0] op_sel_hi:[1,1]
    v_pk_fma_f32 v[24:25], v[250:251], v[24:25], v[120:121] op_sel:[0,0,0] op_sel_hi:[0,1,1]
    v_pk_fma_f32 v[26:27], v[250:251], v[26:27], v[122:123] op_sel:[0,0,0] op_sel_hi:[0,1,1]
    v_pk_fma_f32 v[28:29], v[250:251], v[28:29], v[124:125] op_sel:[0,0,0] op_sel_hi:[0,1,1]
    v_pk_fma_f32 v[30:31], v[250:251], v[30:31], v[126:127] op_sel:[0,0,0] op_sel_hi:[0,1,1]
    v_pk_fma_f32 v[32:33], v[250:251], v[32:33], v[128:129] op_sel:[0,0,0] op_sel_hi:[0,1,1]
    v_pk_fma_f32 v[34:35], v[250:251], v[34:35], v[130:131] op_sel:[0,0,0] op_sel_hi:[0,1,1]
    v_pk_fma_f32 v[36:37], v[250:251], v[36:37], v[132:133] op_sel:[0,0,0] op_sel_hi:[0,1,1]
    v_pk_fma_f32 v[38:39], v[250:251], v[38:39], v[134:135] op_sel:[0,0,0] op_sel_hi:[0,1,1]
    s_waitcnt vmcnt(16)
    v_pk_mul_f32 v[136:137], v[250:251], v[136:137] op_sel:[1,0] op_sel_hi:[1,1]
    v_pk_mul_f32 v[138:139], v[250:251], v[138:139] op_sel:[1,0] op_sel_hi:[1,1]
    v_pk_mul_f32 v[140:141], v[250:251], v[140:141] op_sel:[1,0] op_sel_hi:[1,1]
    v_pk_mul_f32 v[142:143], v[250:251], v[142:143] op_sel:[1,0] op_sel_hi:[1,1]
    v_pk_mul_f32 v[144:145], v[250:251], v[144:145] op_sel:[1,0] op_sel_hi:[1,1]
    v_pk_mul_f32 v[146:147], v[250:251], v[146:147] op_sel:[1,0] op_sel_hi:[1,1]
    v_pk_mul_f32 v[148:149], v[250:251], v[148:149] op_sel:[1,0] op_sel_hi:[1,1]
    v_pk_mul_f32 v[150:151], v[250:251], v[150:151] op_sel:[1,0] op_sel_hi:[1,1]
    v_pk_fma_f32 v[40:41], v[250:251], v[40:41], v[136:137] op_sel:[0,0,0] op_sel_hi:[0,1,1]
    v_pk_fma_f32 v[42:43], v[250:251], v[42:43], v[138:139] op_sel:[0,0,0] op_sel_hi:[0,1,1]
    v_pk_fma_f32 v[44:45], v[250:251], v[44:45], v[140:141] op_sel:[0,0,0] op_sel_hi:[0,1,1]
    v_pk_fma_f32 v[46:47], v[250:251], v[46:47], v[142:143] op_sel:[0,0,0] op_sel_hi:[0,1,1]
    v_pk_fma_f32 v[48:49], v[250:251], v[48:49], v[144:145] op_sel:[0,0,0] op_sel_hi:[0,1,1]
    v_pk_fma_f32 v[50:51], v[250:251], v[50:51], v[146:147] op_sel:[0,0,0] op_sel_hi:[0,1,1]
    v_pk_fma_f32 v[52:53], v[250:251], v[52:53], v[148:149] op_sel:[0,0,0] op_sel_hi:[0,1,1]
    v_pk_fma_f32 v[54:55], v[250:251], v[54:55], v[150:151] op_sel:[0,0,0] op_sel_hi:[0,1,1]
L_pair2:
    s_waitcnt vmcnt(12)
    v_pk_mul_f32 v[152:153], v[252:253], v[152:153] op_sel:[0,0] op_sel_hi:[0,1]
    v_pk_mul_f32 v[154:155], v[252:253], v[154:155] op_sel:[0,0] op_sel_hi:[0,1]
    v_pk_mul_f32 v[156:157], v[252:253], v[156:157] op_sel:[0,0] op_sel_hi:[0,1]
    v_pk_mul_f32 v[158:159], v[252:253], v[158:159] op_sel:[0,0] op_sel_hi:[0,1]
    v_pk_mul_f32 v[160:161], v[252:253], v[160:161] op_sel:[0,0] op_sel_hi:[0,1]
    v_pk_mul_f32 v[162:163], v[252:253], v[162:163] op_sel:[0,0] op_sel_hi:[0,1]
    v_pk_mul_f32 v[164:165], v[252:253], v[164:165] op_sel:[0,0] op_sel_hi:[0,1]
    v_pk_mul_f32 v[166:167], v[252:253], v[166:167] op_sel:[0,0] op_sel_hi:[0,1]
    s_waitcnt vmcnt(8)
    v_pk_mul_f32 v[168:169], v[252:253], v[168:169] op_sel:[0,0] op_sel_hi:[0,1]
    v_pk_mul_f32 v[170:171], v[252:253], v[170:171] op_sel:[0,0] op_sel_hi:[0,1]
    v_pk_mul_f32 v[172:173], v[252:253], v[172:173] op_sel:[0,0] op_sel_hi:[0,1]
    v_pk_mul_f32 v[174:175], v[252:253], v[174:175] op_sel:[0,0] op_sel_hi:[0,1]
    v_pk_mul_f32 v[176:177], v[252:253], v[176:177] op_sel:[0,0] op_sel_hi:[0,1]
    v_pk_mul_f32 v[178:179], v[252:253], v[178:179] op_sel:[0,0] op_sel_hi:[0,1]
    v_pk_mul_f32 v[180:181], v[252:253], v[180:181] op_sel:[0,0] op_sel_hi:[0,1]
    v_pk_mul_f32 v[182:183], v[252:253], v[182:183] op_sel:[0,0] op_sel_hi:[0,1]
    s_waitcnt vmcnt(6)
    v_pk_fma_f32 v[152:153], v[252:253], v[184:185], v[152:153] op_sel:[1,0,0] op_sel_hi:[1,1,1]
    v_pk_fma_f32 v[154:155], v[252:253], v[186:187], v[154:155] op_sel:[1,0,0] op_sel_hi:[1,1,1]
    v_pk_fma_f32 v[156:157], v[252:253], v[188:189], v[156:157] op_sel:[1,0,0] op_sel_hi:[1,1,1]
    v_pk_fma_f32 v[158:159], v[252:253], v[190:191], v[158:159] op_sel:[1,0,0] op_sel_hi:[1,1,1]
    v_pk_add_f32 v[24:25], v[24:25], v[152:153]
    v_pk_add_f32 v[26:27], v[26:27], v[154:155]
    v_pk_add_f32 v[28:29], v[28:29], v[156:157]
    v_pk_add_f32 v[30:31], v[30:31], v[158:159]
    v_cvt_pk_bf16_f32 v88, v24, v25
    v_cvt_pk_bf16_f32 v89, v26, v27
    v_cvt_pk_bf16_f32 v90, v28, v29
    v_cvt_pk_bf16_f32 v91, v30, v31
    s_waitcnt vmcnt(4)
    v_pk_fma_f32 v[160:161], v[252:253], v[192:193], v[160:161] op_sel:[1,0,0] op_sel_hi:[1,1,1]
    v_pk_fma_f32 v[162:163], v[252:253], v[194:195], v[162:163] op_sel:[1,0,0] op_sel_hi:[1,1,1]
    v_pk_fma_f32 v[164:165], v[252:253], v[196:197], v[164:165] op_sel:[1,0,0] op_sel_hi:[1,1,1]
    v_pk_fma_f32 v[166:167], v[252:253], v[198:199], v[166:167] op_sel:[1,0,0] op_sel_hi:[1,1,1]
    v_pk_add_f32 v[32:33], v[32:33], v[160:161]
    v_pk_add_f32 v[34:35], v[34:35], v[162:163]
    v_pk_add_f32 v[36:37], v[36:37], v[164:165]
    v_pk_add_f32 v[38:39], v[38:39], v[166:167]
    v_cvt_pk_bf16_f32 v92, v32, v33
    v_cvt_pk_bf16_f32 v93, v34, v35
    v_cvt_pk_bf16_f32 v94, v36, v37
    v_cvt_pk_bf16_f32 v95, v38, v39
    s_waitcnt vmcnt(2)
    v_pk_fma_f32 v[168:169], v[252:253], v[200:201], v[168:169] op_sel:[1,0,0] op_sel_hi:[1,1,1]
    v_pk_fma_f32 v[170:171], v[252:253], v[202:203], v[170:171] op_sel:[1,0,0] op_sel_hi:[1,1,1]
    v_pk_fma_f32 v[172:173], v[252:253], v[204:205], v[172:173] op_sel:[1,0,0] op_sel_hi:[1,1,1]
    v_pk_fma_f32 v[174:175], v[252:253], v[206:207], v[174:175] op_sel:[1,0,0] op_sel_hi:[1,1,1]
    v_pk_add_f32 v[40:41], v[40:41], v[168:169]
    v_pk_add_f32 v[42:43], v[42:43], v[170:171]
    v_pk_add_f32 v[44:45], v[44:45], v[172:173]
    v_pk_add_f32 v[46:47], v[46:47], v[174:175]
    v_cvt_pk_bf16_f32 v96, v40, v41
    v_cvt_pk_bf16_f32 v97, v42, v43
    v_cvt_pk_bf16_f32 v98, v44, v45
    v_cvt_pk_bf16_f32 v99, v46, v47
    s_waitcnt vmcnt(0)
    v_pk_fma_f32 v[176:177], v[252:253], v[208:209], v[176:177] op_sel:[1,0,0] op_sel_hi:[1,1,1]
    v_pk_fma_f32 v[178:179], v[252:253], v[210:211], v[178:179] op_sel:[1,0,0] op_sel_hi:[1,1,1]
    v_pk_fma_f32 v[180:181], v[252:253], v[212:213], v[180:181] op_sel:[1,0,0] op_sel_hi:[1,1,1]
    v_pk_fma_f32 v[182:183], v[252:253], v[214:215], v[182:183] op_sel:[1,0,0] op_sel_hi:[1,1,1]
    v_pk_add_f32 v[48:49], v[48:49], v[176:177]
    v_pk_add_f32 v[50:51], v[50:51], v[178:179]
    v_pk_add_f32 v[52:53], v[52:53], v[180:181]
    v_pk_add_f32 v[54:55], v[54:55], v[182:183]
    v_cvt_pk_bf16_f32 v100, v48, v49
    v_cvt_pk_bf16_f32 v101, v50, v51
    v_cvt_pk_bf16_f32 v102, v52, v53
    v_cvt_pk_bf16_f32 v103, v54, v55
    s_nop 1
    v_permlane16_swap_b32 v88, v90
    v_permlane16_swap_b32 v89, v91
    buffer_store_dwordx4 v[88:91], v243, s[40:43], s62 offen offset:0
    v_permlane16_swap_b32 v92, v94
    v_permlane16_swap_b32 v93, v95
    buffer_store_dwordx4 v[92:95], v243, s[40:43], s62 offen offset:64
    v_permlane16_swap_b32 v96, v98
    v_permlane16_swap_b32 v97, v99
    buffer_store_dwordx4 v[96:99], v243, s[40:43], s62 offen offset:128
    v_permlane16_swap_b32 v100, v102
    v_permlane16_swap_b32 v101, v103
    buffer_store_dwordx4 v[100:103], v243, s[40:43], s62 offen offset:192
    s_branch L_done
L_publish:
    buffer_store_dwordx4 v[24:27], v238, s[36:39], s60 offen offset:0 sc1
    buffer_store_dwordx4 v[28:31], v238, s[36:39], s60 offen offset:1024 sc1
    buffer_store_dwordx4 v[32:35], v238, s[36:39], s60 offen offset:2048 sc1
    buffer_store_dwordx4 v[36:39], v238, s[36:39], s60 offen offset:3072 sc1
    buffer_store_dwordx4 v[40:43], v239, s[36:39], s60 offen offset:0 sc1
    buffer_store_dwordx4 v[44:47], v239, s[36:39], s60 offen offset:1024 sc1
    buffer_store_dwordx4 v[48:51], v239, s[36:39], s60 offen offset:2048 sc1
    buffer_store_dwordx4 v[52:55], v239, s[36:39], s60 offen offset:3072 sc1
    buffer_store_dwordx2 v[10:11], v240, s[36:39], s61 offen sc1
    s_xor_b32 s56, s56, 1
    v_mov_b32 v9, s56
    s_mov_b64 exec, 1
    s_waitcnt vmcnt(0)
    global_store_dword v1, v9, s[50:51] sc1
L_done:
L_end:
    s_endpgm
.section .rodata,"a"
.p2align 6
.amdhsa_kernel standalone__gqa_softmax__sampling_kernel
  .amdhsa_next_free_vgpr 352
  .amdhsa_next_free_sgpr 96
  .amdhsa_accum_offset 256
  .amdhsa_group_segment_fixed_size 0
  .amdhsa_kernarg_size 48
  .amdhsa_user_sgpr_count 2
  .amdhsa_user_sgpr_kernarg_segment_ptr 1
  .amdhsa_system_sgpr_workgroup_id_x 1
  .amdhsa_float_denorm_mode_32 3
.end_amdhsa_kernel
```
